```python
import torch

def _softmax(x, axis=-1):
    return torch.softmax(x, dim=axis)

def _gelu(x):
    return torch.nn.functional.gelu(x, approximate='tanh')

def _silu(x):
    return torch.nn.functional.silu(x)

def _sigmoid(x):
    return torch.sigmoid(x)

def _layernorm(x, axis=-1, eps=1e-05):
    m = x.mean(dim=axis, keepdim=True)
    v = x.var(dim=axis, keepdim=True, unbiased=False)
    return (x - m) / torch.sqrt(v + eps)

def _scatter_add(tgt, idx, src, axis=0):
    return tgt.clone().index_add_(axis, idx, src)

def _segment_sum(src, seg, n):
    out = torch.zeros((n,) + src.shape[1:], dtype=src.dtype)
    return out.index_add_(0, seg, src)

def _pad(x, pw):
    flat = tuple((v for pair in reversed(pw) for v in pair))
    return torch.nn.functional.pad(x, flat)
kernel_name = 'adaLN_cond__gqa_block_cached__mixer_channel_mlp__decode'

def setup_inputs():

    _w = lambda a: (lambda t: t.to(torch.bfloat16) if t.is_floating_point() else t)(torch.as_tensor(a))

    def _A_setup():
        B, Sq, D = (1, 1, 1024)
        Hq, Hkv, Sk, Dh = (32, 4, 65536, 128)
        assert Hq % Hkv == 0, (Hq, Hkv)
        return {'x': _w((lambda *s: torch.randn(*s, dtype=torch.bfloat16) * 0.1)(B, Sq, D)), 'k_cache': _w((lambda *s: torch.randn(*s, dtype=torch.bfloat16) * 0.8)(B, Hkv, Sk, Dh)), 'v_cache': _w((lambda *s: torch.randn(*s, dtype=torch.bfloat16) * 0.8)(B, Hkv, Sk, Dh)), 'wq': _w((lambda *s: torch.randn(*s, dtype=torch.bfloat16) * 0.8)(D, Hq * Dh) * D ** (-0.5)), 'wo': _w((lambda *s: torch.randn(*s, dtype=torch.bfloat16) * 0.8)(Hq * Dh, D) * (Hq * Dh) ** (-0.5))}
    _A_in = _A_setup()

    def _B_setup():
        B, S, D, F = (1, 1, 1024, 3584)
        return {'x': _w((lambda *s: torch.randn(*s, dtype=torch.bfloat16) * 0.1)(B, S, D)), 'w1': _w((lambda *s: torch.randn(*s, dtype=torch.bfloat16) * 3.2)(D, F) * D ** (-0.5)), 'b1': _w((lambda *s: torch.randn(*s, dtype=torch.bfloat16) * 3.2)(F)), 'w2': _w((lambda *s: torch.randn(*s, dtype=torch.bfloat16) * 3.2)(F, D) * F ** (-0.5)), 'b2': _w((lambda *s: torch.randn(*s, dtype=torch.bfloat16) * 3.2)(D))}
    _B_in = _B_setup()
    return {'A_x': _A_in['x'], 'A_k_cache': _A_in['k_cache'], 'A_v_cache': _A_in['v_cache'], 'A_wq': _A_in['wq'], 'A_wo': _A_in['wo'], 'B_x': _B_in['x'], 'B_w1': _B_in['w1'], 'B_b1': _B_in['b1'], 'B_w2': _B_in['w2'], 'B_b2': _B_in['b2'], 'c': _w((lambda *s: torch.randn(*s, dtype=torch.bfloat16) * 0.4)(1, 1024) * 8.0), 'w_mod': _w((lambda *s: torch.randn(*s, dtype=torch.bfloat16) * 0.4)(1024, 6 * 1024) * 1024 ** (-0.5) * 8.0)}

def reference(A_x, A_k_cache, A_v_cache, A_wq, A_wo, B_x, B_w1, B_b1, B_w2, B_b2, c, w_mod):

    def _A_ref(x, k_cache, v_cache, wq, wo):
        B, Sq, D = x.shape
        Hq, Dh = (32, 128)
        Hkv = k_cache.shape[1]
        rep = Hq // Hkv
        q = (lambda x, *d: x.permute(*d))((x @ wq).reshape(B, Sq, Hq, Dh), 0, 2, 1, 3)
        k = (lambda x, n, axis: torch.repeat_interleave(x, n, dim=axis))(k_cache, rep, axis=1)
        v = (lambda x, n, axis: torch.repeat_interleave(x, n, dim=axis))(v_cache, rep, axis=1)
        scores = torch.einsum('bhqd,bhkd->bhqk', q, k) * Dh ** (-0.5)
        p = _softmax(scores, axis=-1)
        o = torch.einsum('bhqk,bhkd->bhqd', p, v)
        return (lambda x, *d: x.permute(*d))(o, 0, 2, 1, 3).reshape(B, Sq, Hq * Dh) @ wo

    def _B_ref(x, w1, b1, w2, b2):
        y = _layernorm(x, axis=-1)
        h = _gelu(torch.einsum('bsd,df->bsf', y, w1) + b1)
        return torch.einsum('bsf,fd->bsd', h, w2) + b2
    x = A_x
    mod = (_silu(c) @ w_mod).reshape(c.shape[0], 6, 1, -1)
    sa, ca, ga, sb, cb, gb = (mod[:, 0].clone(), mod[:, 1].clone(), mod[:, 2].clone(), mod[:, 3].clone(), mod[:, 4].clone(), mod[:, 5].clone())
    h = _layernorm(x, axis=-1) * (1 + ca) + sa
    x = x + ga * _A_ref(h, A_k_cache, A_v_cache, A_wq, A_wo)
    h = _layernorm(x, axis=-1) * (1 + cb) + sb
    x = x + gb * _B_ref(h, B_w1, B_b1, B_w2, B_b2)
    return x
```

```asm
; @launch grid=(256,1,1) block=(768,1,1) lds=163840
.amdgcn_target "amdgcn-amd-amdhsa--gfx950"
.text
.globl adaLN_cond__gqa_block_cached__mixer_channel_mlp__decode_kernel
.p2align 8
.type adaLN_cond__gqa_block_cached__mixer_channel_mlp__decode_kernel,@function
adaLN_cond__gqa_block_cached__mixer_channel_mlp__decode_kernel:
  s_cmp_ge_u32 s2, 256
  s_cbranch_scc1 L_exit
  s_load_dwordx16 s[32:47], s[0:1], 0
  s_load_dwordx8 s[48:55], s[0:1], 64
  s_load_dwordx4 s[56:59], s[0:1], 96
  s_load_dwordx2 s[60:61], s[0:1], 112
  v_lshrrev_b32 v1, 6, v0
  v_and_b32 v0, 63, v0
  v_mov_b32 v3, 0
  v_readfirstlane_b32 s3, v1
  v_lshlrev_b32 v2, 4, v0
  s_mov_b32 s62, 0x05040100
  s_mov_b32 s63, 0x07060302
  s_and_b32 s24, s2, 63
  s_lshr_b32 s25, s2, 6
  s_mov_b64 s[26:27], -1
  s_mov_b32 s69, 0
  s_cmp_ge_u32 s3, 8
  s_cbranch_scc1 L_role
  s_mov_b32 s5, s3
  s_mul_i32 s65, s24, 26
  s_add_u32 s65, s65, 0x0
  s_mov_b32 s64, s65
  s_mov_b32 s66, 26
  s_mul_i32 s65, s24, 24
  s_add_u32 s65, s65, 0x10
  s_cmp_ge_u32 s24, 8
  s_cselect_b32 s64, s65, s64
  s_cselect_b32 s66, 24, s66
  s_mul_i32 s65, s24, 28
  s_add_u32 s65, s65, 0xffffffb8
  s_cmp_ge_u32 s24, 22
  s_cselect_b32 s64, s65, s64
  s_cselect_b32 s66, 28, s66
  s_mul_i32 s65, s24, 24
  s_add_u32 s65, s65, 0x18
  s_cmp_ge_u32 s24, 24
  s_cselect_b32 s64, s65, s64
  s_cselect_b32 s66, 24, s66
  s_mul_i32 s65, s24, 26
  s_add_u32 s65, s65, 0xffffffd8
  s_cmp_ge_u32 s24, 32
  s_cselect_b32 s64, s65, s64
  s_cselect_b32 s66, 26, s66
  s_mul_i32 s65, s24, 26
  s_add_u32 s65, s65, 0xffffffd8
  s_cmp_ge_u32 s24, 48
  s_cselect_b32 s64, s65, s64
  s_cselect_b32 s66, 26, s66
  s_lshl_b32 s7, s64, 13
  s_lshl_b32 s64, s25, 24
  s_add_u32 s7, s7, s64
  s_lshl_b32 s64, s3, 12
  s_add_u32 s7, s7, s64
  s_and_b32 s65, s66, 7
  s_lshr_b32 s66, s66, 3
  s_sub_u32 s67, 8, s65
  s_lshl_b32 s100, s65, 12
  s_lshl_b32 s28, s67, 12
  s_cmp_ge_u32 s3, s67
  s_cselect_b32 s100, s100, 0x8000
  s_cselect_b32 s28, s28, 0
  s_addc_u32 s66, s66, 0
  s_sub_u32 s64, s66, 1
  s_lshl_b32 s64, s64, 16
  s_add_u32 s64, s64, s7
  s_sub_u32 s28, s64, s28
  s_add_u32 s100, s100, s28
  s_add_u32 s101, s7, 0x18000
  s_cmp_eq_u32 s66, 2
  s_cselect_b32 s101, s100, s101
  v_bfe_u32 v1, v0, 2, 2
  v_lshlrev_b32 v1, 8, v1
  v_lshrrev_b32 v4, 4, v0
  v_lshl_add_u32 v1, v4, 6, v1
  v_and_b32 v4, 3, v0
  v_lshl_add_u32 v1, v4, 4, v1
  v_and_b32 v5, 7, v0
  v_lshlrev_b32 v5, 8, v5
  v_lshrrev_b32 v6, 4, v0
  v_lshl_add_u32 v5, v6, 6, v5
  v_bfe_u32 v6, v0, 3, 1
  v_lshl_add_u32 v5, v6, 4, v5
  s_mov_b32 s78, 0x3db504f3
  s_mov_b32 s79, 0x3fb8aa3b
  s_lshl_b32 s64, s3, 9
  v_lshlrev_b32 v24, 3, v0
  v_add_u32 v24, s64, v24
  v_lshrrev_b32 v26, 5, v0
  v_lshlrev_b32 v26, 10, v26
  v_lshrrev_b32 v4, 3, v0
  v_subrev_u32 v4, s3, v4
  v_and_b32 v4, 7, v4
  v_and_b32 v25, 3, v4
  v_lshlrev_b32 v25, 4, v25
  v_lshrrev_b32 v4, 2, v4
  v_lshl_add_u32 v25, v4, 13, v25
  v_and_b32 v4, 1, v0
  v_lshl_add_u32 v25, v4, 14, v25
  v_bfe_u32 v4, v0, 1, 1
  v_lshl_add_u32 v25, v4, 6, v25
  v_bfe_u32 v4, v0, 2, 1
  v_lshl_add_u32 v25, v4, 15, v25
  s_lshl_b32 s64, s25, 3
  s_add_u32 s64, s64, s3
  s_lshl_b32 s82, s64, 16
  s_lshl_b32 s65, s24, 7
  s_add_u32 s82, s82, s65
  s_add_u32 s82, s82, 0x300000
  s_lshl_b32 s83, s64, 11
  s_lshl_b32 s65, s24, 4
  s_add_u32 s83, s83, s65
  s_add_u32 s83, s83, 0x290000
  s_waitcnt lgkmcnt(0)
  s_load_dword s4, s[60:61], 0
  s_mov_b32 s16, s60
  s_and_b32 s17, s61, 0xffff
  s_mov_b32 s18, 0x10000000
  s_mov_b32 s19, 0x20000
  s_mov_b32 s8, s34
  s_and_b32 s9, s35, 0xffff
  s_mov_b32 s10, 0x4000000
  s_mov_b32 s11, 0x20000
  s_mov_b32 s12, s36
  s_and_b32 s13, s37, 0xffff
  s_mov_b32 s14, 0x4000000
  s_mov_b32 s15, 0x20000
  s_sub_u32 s64, s24, 8
  s_sub_u32 s64, s24, 32
  s_cmp_lt_u32 s64, 16
  s_cbranch_scc1 L_st_hold
  s_add_u32 s64, s7, 0x0
  buffer_load_dwordx4 v[76:79], v1, s[8:11], s64 offen offset:0 nt
  s_barrier
  s_branch L_st_go
L_st_hold:
  s_barrier
  s_mov_b32 s68, 0
L_w_1:
  s_sleep 1
  s_add_u32 s68, s68, 1
  s_cmp_gt_u32 s68, 0x400000
  s_cbranch_scc1 L_fail
  ds_read_b32 v4, v3 offset:28
  s_waitcnt lgkmcnt(0)
  v_readfirstlane_b32 s67, v4
  s_nop 0
  s_cmp_ge_u32 s67, 4
  s_cbranch_execz L_wd_2
  s_cbranch_scc0 L_w_1
L_wd_2:
  s_add_u32 s64, s7, 0x0
  buffer_load_dwordx4 v[76:79], v1, s[8:11], s64 offen offset:0 nt
L_st_go:
  s_waitcnt vmcnt(3)
  s_add_u32 s64, s7, 0x0
  buffer_load_dwordx4 v[80:83], v1, s[8:11], s64 offen offset:1024 nt
  s_waitcnt vmcnt(3)
  s_add_u32 s64, s7, 0x0
  buffer_load_dwordx4 v[84:87], v1, s[8:11], s64 offen offset:2048 nt
  s_waitcnt vmcnt(3)
  s_add_u32 s64, s7, 0x0
  buffer_load_dwordx4 v[88:91], v1, s[8:11], s64 offen offset:3072 nt
  s_waitcnt vmcnt(3)
  s_add_u32 s64, s7, 0x8000
  buffer_load_dwordx4 v[92:95], v1, s[8:11], s64 offen offset:0 nt
  s_waitcnt vmcnt(3)
  s_add_u32 s64, s7, 0x8000
  buffer_load_dwordx4 v[96:99], v1, s[8:11], s64 offen offset:1024 nt
  s_waitcnt vmcnt(3)
  s_add_u32 s64, s7, 0x8000
  buffer_load_dwordx4 v[100:103], v1, s[8:11], s64 offen offset:2048 nt
  s_waitcnt vmcnt(3)
  s_add_u32 s64, s7, 0x8000
  buffer_load_dwordx4 v[104:107], v1, s[8:11], s64 offen offset:3072 nt
  s_waitcnt vmcnt(3)
  s_add_u32 s64, s7, 0x10000
  buffer_load_dwordx4 v[108:111], v1, s[8:11], s64 offen offset:0 nt
  s_waitcnt lgkmcnt(0)
  s_add_u32 s4, s4, 1
  s_waitcnt vmcnt(3)
  s_add_u32 s64, s7, 0x10000
  buffer_load_dwordx4 v[112:115], v1, s[8:11], s64 offen offset:1024 nt
  s_waitcnt vmcnt(3)
  s_add_u32 s64, s7, 0x10000
  buffer_load_dwordx4 v[116:119], v1, s[8:11], s64 offen offset:2048 nt
  s_waitcnt vmcnt(3)
  s_add_u32 s64, s7, 0x10000
  buffer_load_dwordx4 v[120:123], v1, s[8:11], s64 offen offset:3072 nt
  s_waitcnt vmcnt(3)
  buffer_load_dwordx4 v[124:127], v1, s[8:11], s101 offen offset:0 nt
  s_waitcnt vmcnt(3)
  buffer_load_dwordx4 v[128:131], v1, s[8:11], s101 offen offset:1024 nt
  s_waitcnt vmcnt(3)
  buffer_load_dwordx4 v[132:135], v1, s[8:11], s101 offen offset:2048 nt
  s_waitcnt vmcnt(3)
  buffer_load_dwordx4 v[136:139], v1, s[8:11], s101 offen offset:3072 nt
  s_cmp_eq_u32 s66, 3
  s_cbranch_scc1 L_st_n3l
  s_lshl_b32 s80, s2, 12
  s_lshl_b32 s64, s5, 10
  s_add_u32 s80, s80, s64
  s_add_u32 s80, s80, 0x100000
  s_cmp_ge_u32 s3, 4
  s_cselect_b32 s29, 1, 0
  s_add_u32 s64, s7, 0x20000
  s_waitcnt vmcnt(3)
  buffer_load_dwordx4 v[140:143], v1, s[8:11], s64 offen offset:0 nt
  s_add_u32 s64, s7, 0x20000
  s_waitcnt vmcnt(3)
  buffer_load_dwordx4 v[144:147], v1, s[8:11], s64 offen offset:1024 nt
  s_add_u32 s64, s7, 0x20000
  s_waitcnt vmcnt(3)
  buffer_load_dwordx4 v[148:151], v1, s[8:11], s64 offen offset:2048 nt
  s_add_u32 s64, s7, 0x20000
  s_waitcnt vmcnt(3)
  buffer_load_dwordx4 v[152:155], v1, s[8:11], s64 offen offset:3072 nt
  s_add_u32 s64, s7, 0x28000
  s_waitcnt vmcnt(3)
  buffer_load_dwordx4 v[156:159], v1, s[8:11], s64 offen offset:0 nt
  s_cmp_lg_u32 s29, 0
  s_cbranch_scc1 L_qi_3
  buffer_load_dwordx4 v[28:31], v2, s[16:19], s80 offen sc1
L_qi_3:
  s_add_u32 s64, s7, 0x28000
  s_waitcnt vmcnt(3)
  buffer_load_dwordx4 v[160:163], v1, s[8:11], s64 offen offset:1024 nt
  s_add_u32 s64, s7, 0x28000
  s_waitcnt vmcnt(3)
  buffer_load_dwordx4 v[164:167], v1, s[8:11], s64 offen offset:2048 nt
  v_mov_b32 v4, 1
  s_waitcnt lgkmcnt(0)
  s_and_b64 exec, s[26:27], 0x1
  ds_add_u32 v3, v4 offset:36
  s_mov_b64 exec, s[26:27]
  s_mul_i32 s65, s3, 15360
  s_add_u32 s65, s65, 40960
  s_add_u32 s64, s7, 0x28c00
  s_add_u32 m0, s65, 0
  s_waitcnt vmcnt(3)
  buffer_load_dwordx4 v1, s[8:11], s64 offen nt lds
  s_add_u32 s64, s28, 0x0
  s_add_u32 m0, s65, 1024
  s_waitcnt vmcnt(3)
  buffer_load_dwordx4 v1, s[8:11], s64 offen nt lds
  s_add_u32 s64, s28, 0x400
  s_add_u32 m0, s65, 2048
  s_waitcnt vmcnt(3)
  buffer_load_dwordx4 v1, s[8:11], s64 offen nt lds
  s_cmp_lg_u32 s29, 0
  s_cbranch_scc1 L_qc_4
  v_cmp_eq_u32 vcc, s4, v29
  v_cmp_eq_u32 s[76:77], s4, v31
  s_nop 0
  s_and_b64 vcc, vcc, s[76:77]
  s_cmp_eq_u64 vcc, -1
  s_cbranch_scc0 L_qc_4
  v_mov_b32 v29, v30
  s_lshl_b32 s67, s5, 9
  v_lshlrev_b32 v4, 3, v0
  v_add_u32 v4, s67, v4
  ds_write_b64 v4, v[28:29] offset:256
  v_mov_b32 v4, 1
  s_waitcnt lgkmcnt(0)
  s_and_b64 exec, s[26:27], 0x1
  ds_add_u32 v3, v4 offset:0
  s_mov_b64 exec, s[26:27]
  s_mov_b32 s29, 1
L_qc_4:
  s_add_u32 s64, s28, 0x800
  s_add_u32 m0, s65, 3072
  s_waitcnt vmcnt(3)
  buffer_load_dwordx4 v1, s[8:11], s64 offen nt lds
  s_cmp_lg_u32 s29, 0
  s_cbranch_scc1 L_qi_5
  buffer_load_dwordx4 v[28:31], v2, s[16:19], s80 offen sc1
L_qi_5:
  s_add_u32 s64, s28, 0xc00
  s_add_u32 m0, s65, 4096
  s_waitcnt vmcnt(3)
  buffer_load_dwordx4 v1, s[8:11], s64 offen nt lds
  s_add_u32 s64, s100, 0x0
  s_add_u32 m0, s65, 5120
  s_waitcnt vmcnt(3)
  buffer_load_dwordx4 v1, s[8:11], s64 offen nt lds
  s_add_u32 s64, s100, 0x400
  s_add_u32 m0, s65, 6144
  s_waitcnt vmcnt(3)
  buffer_load_dwordx4 v1, s[8:11], s64 offen nt lds
  s_add_u32 s64, s100, 0x800
  s_add_u32 m0, s65, 7168
  s_waitcnt vmcnt(3)
  buffer_load_dwordx4 v1, s[8:11], s64 offen nt lds
  s_add_u32 s64, s100, 0xc00
  s_add_u32 m0, s65, 8192
  s_waitcnt vmcnt(3)
  buffer_load_dwordx4 v1, s[8:11], s64 offen nt lds
  s_cmp_lg_u32 s29, 0
  s_cbranch_scc1 L_qc_6
  v_cmp_eq_u32 vcc, s4, v29
  v_cmp_eq_u32 s[76:77], s4, v31
  s_nop 0
  s_and_b64 vcc, vcc, s[76:77]
  s_cmp_eq_u64 vcc, -1
  s_cbranch_scc0 L_qc_6
  v_mov_b32 v29, v30
  s_lshl_b32 s67, s5, 9
  v_lshlrev_b32 v4, 3, v0
  v_add_u32 v4, s67, v4
  ds_write_b64 v4, v[28:29] offset:256
  v_mov_b32 v4, 1
  s_waitcnt lgkmcnt(0)
  s_and_b64 exec, s[26:27], 0x1
  ds_add_u32 v3, v4 offset:0
  s_mov_b64 exec, s[26:27]
  s_mov_b32 s29, 1
L_qc_6:
  s_add_u32 s64, s7, 0x0
  s_add_u32 m0, s65, 9216
  s_waitcnt vmcnt(3)
  buffer_load_dwordx4 v2, s[12:15], s64 offen nt lds
  s_cmp_lg_u32 s29, 0
  s_cbranch_scc1 L_qi_7
  buffer_load_dwordx4 v[28:31], v2, s[16:19], s80 offen sc1
L_qi_7:
  s_add_u32 s64, s7, 0x400
  s_add_u32 m0, s65, 10240
  s_waitcnt vmcnt(3)
  buffer_load_dwordx4 v2, s[12:15], s64 offen nt lds
  s_add_u32 s64, s7, 0x800
  s_add_u32 m0, s65, 11264
  s_waitcnt vmcnt(3)
  buffer_load_dwordx4 v2, s[12:15], s64 offen nt lds
  s_add_u32 s64, s7, 0xc00
  s_add_u32 m0, s65, 12288
  s_waitcnt vmcnt(3)
  buffer_load_dwordx4 v2, s[12:15], s64 offen nt lds
  s_add_u32 s64, s7, 0x8000
  s_add_u32 m0, s65, 13312
  s_waitcnt vmcnt(3)
  buffer_load_dwordx4 v2, s[12:15], s64 offen nt lds
  s_add_u32 s64, s7, 0x8400
  s_add_u32 m0, s65, 14336
  s_waitcnt vmcnt(3)
  buffer_load_dwordx4 v2, s[12:15], s64 offen nt lds
  s_cmp_lg_u32 s29, 0
  s_cbranch_scc1 L_qc_8
  v_cmp_eq_u32 vcc, s4, v29
  v_cmp_eq_u32 s[76:77], s4, v31
  s_nop 0
  s_and_b64 vcc, vcc, s[76:77]
  s_cmp_eq_u64 vcc, -1
  s_cbranch_scc0 L_qc_8
  v_mov_b32 v29, v30
  s_lshl_b32 s67, s5, 9
  v_lshlrev_b32 v4, 3, v0
  v_add_u32 v4, s67, v4
  ds_write_b64 v4, v[28:29] offset:256
  v_mov_b32 v4, 1
  s_waitcnt lgkmcnt(0)
  s_and_b64 exec, s[26:27], 0x1
  ds_add_u32 v3, v4 offset:0
  s_mov_b64 exec, s[26:27]
  s_mov_b32 s29, 1
L_qc_8:
  s_cmp_lg_u32 s29, 0
  s_cbranch_scc1 L_st_qwa
  s_lshl_b32 s80, s2, 12
  s_lshl_b32 s64, s5, 10
  s_add_u32 s80, s80, s64
  s_add_u32 s80, s80, 0x100000
  s_mov_b32 s68, 0
L_p_9:
  s_add_u32 s68, s68, 1
  s_cmp_gt_u32 s68, 0x40000
  s_cbranch_scc1 L_fail
  s_cbranch_execz L_ps_10
  buffer_load_dwordx4 v[28:31], v2, s[16:19], s80 offen offset:0 sc1
  s_waitcnt vmcnt(0)
L_ps_10:
  s_mov_b64 s[70:71], -1
  v_cmp_eq_u32 vcc, s4, v29
  v_cmp_eq_u32 s[76:77], s4, v31
  s_and_b64 s[70:71], s[70:71], vcc
  s_and_b64 s[70:71], s[70:71], s[76:77]
  s_cmp_eq_u64 s[70:71], -1
  s_cbranch_execz L_pd_11
  s_cbranch_scc1 L_pd_11
  s_sleep 16
  s_branch L_p_9
L_pd_11:
  v_mov_b32 v29, v30
  s_lshl_b32 s67, s5, 9
  v_lshlrev_b32 v4, 3, v0
  v_add_u32 v4, s67, v4
  ds_write_b64 v4, v[28:29] offset:256
  v_mov_b32 v4, 1
  s_waitcnt lgkmcnt(0)
  s_and_b64 exec, s[26:27], 0x1
  ds_add_u32 v3, v4 offset:0
  s_mov_b64 exec, s[26:27]
L_st_qwa:
  s_mov_b32 s68, 0
L_w_12:
  s_sleep 2
  s_add_u32 s68, s68, 1
  s_cmp_gt_u32 s68, 0x400000
  s_cbranch_scc1 L_fail
  ds_read_b32 v4, v3 offset:0
  s_waitcnt lgkmcnt(0)
  v_readfirstlane_b32 s67, v4
  s_nop 0
  s_cmp_ge_u32 s67, 4
  s_cbranch_execz L_wd_13
  s_cbranch_scc0 L_w_12
L_wd_13:
  ds_read_b128 v[60:63], v5 offset:256
  ds_read_b128 v[64:67], v5 offset:288
  s_mul_i32 s65, s3, 15360
  s_add_u32 s65, s65, 40960
  v_add_u32 v4, s65, v2
  s_waitcnt lgkmcnt(0)
  s_waitcnt vmcnt(36)
  v_mfma_f32_16x16x32_bf16 v[28:31], v[76:79], v[60:63], 0
  v_mfma_f32_16x16x32_bf16 v[32:35], v[76:79], v[64:67], 0
  v_mfma_f32_16x16x32_bf16 v[36:39], v[80:83], v[60:63], 0
  v_mfma_f32_16x16x32_bf16 v[40:43], v[80:83], v[64:67], 0
  s_waitcnt vmcnt(34)
  v_mfma_f32_16x16x32_bf16 v[44:47], v[84:87], v[60:63], 0
  v_mfma_f32_16x16x32_bf16 v[48:51], v[84:87], v[64:67], 0
  v_mfma_f32_16x16x32_bf16 v[52:55], v[88:91], v[60:63], 0
  v_mfma_f32_16x16x32_bf16 v[56:59], v[88:91], v[64:67], 0
  s_nop 0
  v_add_f32 v68, v28, v34
  v_add_f32 v69, v29, v35
  v_add_f32 v70, v36, v42
  v_add_f32 v71, v37, v43
  v_add_f32_dpp v8, v69, v68 row_ror:8 row_mask:0xf bank_mask:0x3
  s_nop 1
  v_add_f32_dpp v8, v70, v71 row_ror:8 row_mask:0xf bank_mask:0xc
  s_add_u32 s64, s7, 0x8000
  s_waitcnt vmcnt(7)
  buffer_load_dwordx4 v[76:79], v2, s[12:15], s64 offen offset:2048 nt
  s_add_u32 s64, s7, 0x8000
  s_waitcnt vmcnt(7)
  buffer_load_dwordx4 v[80:83], v2, s[12:15], s64 offen offset:3072 nt
  s_waitcnt vmcnt(34)
  v_mfma_f32_16x16x32_bf16 v[28:31], v[92:95], v[60:63], 0
  v_mfma_f32_16x16x32_bf16 v[32:35], v[92:95], v[64:67], 0
  v_mfma_f32_16x16x32_bf16 v[36:39], v[96:99], v[60:63], 0
  v_mfma_f32_16x16x32_bf16 v[40:43], v[96:99], v[64:67], 0
  v_add_f32 v68, v44, v50
  v_add_f32 v69, v45, v51
  v_add_f32 v70, v52, v58
  v_add_f32 v71, v53, v59
  v_add_f32_dpp v9, v69, v68 row_ror:8 row_mask:0xf bank_mask:0x3
  s_nop 1
  v_add_f32_dpp v9, v70, v71 row_ror:8 row_mask:0xf bank_mask:0xc
  s_add_u32 s64, s7, 0x10000
  s_waitcnt vmcnt(7)
  buffer_load_dwordx4 v[84:87], v2, s[12:15], s64 offen offset:0 nt
  s_add_u32 s64, s7, 0x10000
  s_waitcnt vmcnt(7)
  buffer_load_dwordx4 v[88:91], v2, s[12:15], s64 offen offset:1024 nt
  s_waitcnt vmcnt(34)
  v_mfma_f32_16x16x32_bf16 v[44:47], v[100:103], v[60:63], 0
  v_mfma_f32_16x16x32_bf16 v[48:51], v[100:103], v[64:67], 0
  v_mfma_f32_16x16x32_bf16 v[52:55], v[104:107], v[60:63], 0
  v_mfma_f32_16x16x32_bf16 v[56:59], v[104:107], v[64:67], 0
  v_add_f32 v68, v28, v34
  v_add_f32 v69, v29, v35
  v_add_f32 v70, v36, v42
  v_add_f32 v71, v37, v43
  v_add_f32_dpp v10, v69, v68 row_ror:8 row_mask:0xf bank_mask:0x3
  s_nop 1
  v_add_f32_dpp v10, v70, v71 row_ror:8 row_mask:0xf bank_mask:0xc
  s_add_u32 s64, s7, 0x10000
  s_waitcnt vmcnt(7)
  buffer_load_dwordx4 v[92:95], v2, s[12:15], s64 offen offset:2048 nt
  s_add_u32 s64, s7, 0x10000
  s_waitcnt vmcnt(7)
  buffer_load_dwordx4 v[96:99], v2, s[12:15], s64 offen offset:3072 nt
  s_waitcnt vmcnt(34)
  v_mfma_f32_16x16x32_bf16 v[28:31], v[108:111], v[60:63], 0
  v_mfma_f32_16x16x32_bf16 v[32:35], v[108:111], v[64:67], 0
  v_mfma_f32_16x16x32_bf16 v[36:39], v[112:115], v[60:63], 0
  v_mfma_f32_16x16x32_bf16 v[40:43], v[112:115], v[64:67], 0
  v_add_f32 v68, v44, v50
  v_add_f32 v69, v45, v51
  v_add_f32 v70, v52, v58
  v_add_f32 v71, v53, v59
  v_add_f32_dpp v11, v69, v68 row_ror:8 row_mask:0xf bank_mask:0x3
  s_nop 1
  v_add_f32_dpp v11, v70, v71 row_ror:8 row_mask:0xf bank_mask:0xc
  s_add_u32 s64, s7, 0x18000
  s_waitcnt vmcnt(7)
  buffer_load_dwordx4 v[100:103], v2, s[12:15], s64 offen offset:0 nt
  s_add_u32 s64, s7, 0x18000
  s_waitcnt vmcnt(7)
  buffer_load_dwordx4 v[104:107], v2, s[12:15], s64 offen offset:1024 nt
  s_waitcnt vmcnt(34)
  v_mfma_f32_16x16x32_bf16 v[44:47], v[116:119], v[60:63], 0
  v_mfma_f32_16x16x32_bf16 v[48:51], v[116:119], v[64:67], 0
  v_mfma_f32_16x16x32_bf16 v[52:55], v[120:123], v[60:63], 0
  v_mfma_f32_16x16x32_bf16 v[56:59], v[120:123], v[64:67], 0
  v_add_f32 v68, v28, v34
  v_add_f32 v69, v29, v35
  v_add_f32 v70, v36, v42
  v_add_f32 v71, v37, v43
  v_add_f32_dpp v12, v69, v68 row_ror:8 row_mask:0xf bank_mask:0x3
  s_nop 1
  v_add_f32_dpp v12, v70, v71 row_ror:8 row_mask:0xf bank_mask:0xc
  s_add_u32 s64, s7, 0x18000
  s_waitcnt vmcnt(7)
  buffer_load_dwordx4 v[108:111], v2, s[12:15], s64 offen offset:2048 nt
  s_add_u32 s64, s7, 0x18000
  s_waitcnt vmcnt(7)
  buffer_load_dwordx4 v[112:115], v2, s[12:15], s64 offen offset:3072 nt
  s_waitcnt vmcnt(34)
  v_mfma_f32_16x16x32_bf16 v[28:31], v[124:127], v[60:63], 0
  v_mfma_f32_16x16x32_bf16 v[32:35], v[124:127], v[64:67], 0
  v_mfma_f32_16x16x32_bf16 v[36:39], v[128:131], v[60:63], 0
  v_mfma_f32_16x16x32_bf16 v[40:43], v[128:131], v[64:67], 0
  v_add_f32 v68, v44, v50
  v_add_f32 v69, v45, v51
  v_add_f32 v70, v52, v58
  v_add_f32 v71, v53, v59
  v_add_f32_dpp v13, v69, v68 row_ror:8 row_mask:0xf bank_mask:0x3
  s_nop 1
  v_add_f32_dpp v13, v70, v71 row_ror:8 row_mask:0xf bank_mask:0xc
  s_add_u32 s64, s7, 0x20000
  s_waitcnt vmcnt(7)
  buffer_load_dwordx4 v[116:119], v2, s[12:15], s64 offen offset:0 nt
  s_add_u32 s64, s7, 0x20000
  s_waitcnt vmcnt(7)
  buffer_load_dwordx4 v[120:123], v2, s[12:15], s64 offen offset:1024 nt
  s_waitcnt vmcnt(34)
  v_mfma_f32_16x16x32_bf16 v[44:47], v[132:135], v[60:63], 0
  v_mfma_f32_16x16x32_bf16 v[48:51], v[132:135], v[64:67], 0
  v_mfma_f32_16x16x32_bf16 v[52:55], v[136:139], v[60:63], 0
  v_mfma_f32_16x16x32_bf16 v[56:59], v[136:139], v[64:67], 0
  v_add_f32 v68, v28, v34
  v_add_f32 v69, v29, v35
  v_add_f32 v70, v36, v42
  v_add_f32 v71, v37, v43
  v_add_f32_dpp v14, v69, v68 row_ror:8 row_mask:0xf bank_mask:0x3
  s_nop 1
  v_add_f32_dpp v14, v70, v71 row_ror:8 row_mask:0xf bank_mask:0xc
  s_add_u32 s64, s7, 0x20000
  s_waitcnt vmcnt(7)
  buffer_load_dwordx4 v[124:127], v2, s[12:15], s64 offen offset:2048 nt
  s_add_u32 s64, s7, 0x20000
  s_waitcnt vmcnt(7)
  buffer_load_dwordx4 v[128:131], v2, s[12:15], s64 offen offset:3072 nt
  s_waitcnt vmcnt(34)
  v_mfma_f32_16x16x32_bf16 v[28:31], v[140:143], v[60:63], 0
  v_mfma_f32_16x16x32_bf16 v[32:35], v[140:143], v[64:67], 0
  v_mfma_f32_16x16x32_bf16 v[36:39], v[144:147], v[60:63], 0
  v_mfma_f32_16x16x32_bf16 v[40:43], v[144:147], v[64:67], 0
  v_add_f32 v68, v44, v50
  v_add_f32 v69, v45, v51
  v_add_f32 v70, v52, v58
  v_add_f32 v71, v53, v59
  v_add_f32_dpp v15, v69, v68 row_ror:8 row_mask:0xf bank_mask:0x3
  s_nop 1
  v_add_f32_dpp v15, v70, v71 row_ror:8 row_mask:0xf bank_mask:0xc
  s_add_u32 s64, s7, 0x28000
  s_waitcnt vmcnt(7)
  buffer_load_dwordx4 v[132:135], v2, s[12:15], s64 offen offset:0 nt
  s_waitcnt vmcnt(33)
  v_mfma_f32_16x16x32_bf16 v[44:47], v[148:151], v[60:63], 0
  v_mfma_f32_16x16x32_bf16 v[48:51], v[148:151], v[64:67], 0
  v_mfma_f32_16x16x32_bf16 v[52:55], v[152:155], v[60:63], 0
  v_mfma_f32_16x16x32_bf16 v[56:59], v[152:155], v[64:67], 0
  v_add_f32 v68, v28, v34
  v_add_f32 v69, v29, v35
  v_add_f32 v70, v36, v42
  v_add_f32 v71, v37, v43
  v_add_f32_dpp v16, v69, v68 row_ror:8 row_mask:0xf bank_mask:0x3
  s_nop 1
  v_add_f32_dpp v16, v70, v71 row_ror:8 row_mask:0xf bank_mask:0xc
  s_waitcnt vmcnt(31)
  v_mfma_f32_16x16x32_bf16 v[28:31], v[156:159], v[60:63], 0
  v_mfma_f32_16x16x32_bf16 v[32:35], v[156:159], v[64:67], 0
  v_mfma_f32_16x16x32_bf16 v[36:39], v[160:163], v[60:63], 0
  v_mfma_f32_16x16x32_bf16 v[40:43], v[160:163], v[64:67], 0
  v_add_f32 v68, v44, v50
  v_add_f32 v69, v45, v51
  v_add_f32 v70, v52, v58
  v_add_f32 v71, v53, v59
  v_add_f32_dpp v17, v69, v68 row_ror:8 row_mask:0xf bank_mask:0x3
  s_nop 1
  v_add_f32_dpp v17, v70, v71 row_ror:8 row_mask:0xf bank_mask:0xc
  s_waitcnt vmcnt(29)
  ds_read_b128 v[136:139], v4 offset:0
  s_waitcnt vmcnt(30)
  s_waitcnt lgkmcnt(0)
  v_mfma_f32_16x16x32_bf16 v[44:47], v[164:167], v[60:63], 0
  v_mfma_f32_16x16x32_bf16 v[48:51], v[164:167], v[64:67], 0
  v_mfma_f32_16x16x32_bf16 v[52:55], v[136:139], v[60:63], 0
  v_mfma_f32_16x16x32_bf16 v[56:59], v[136:139], v[64:67], 0
  v_add_f32 v68, v28, v34
  v_add_f32 v69, v29, v35
  v_add_f32 v70, v36, v42
  v_add_f32 v71, v37, v43
  v_add_f32_dpp v18, v69, v68 row_ror:8 row_mask:0xf bank_mask:0x3
  s_nop 1
  v_add_f32_dpp v18, v70, v71 row_ror:8 row_mask:0xf bank_mask:0xc
  s_waitcnt vmcnt(28)
  ds_read_b128 v[140:143], v4 offset:1024
  s_waitcnt vmcnt(27)
  ds_read_b128 v[144:147], v4 offset:2048
  s_waitcnt lgkmcnt(0)
  v_mfma_f32_16x16x32_bf16 v[28:31], v[140:143], v[60:63], 0
  v_mfma_f32_16x16x32_bf16 v[32:35], v[140:143], v[64:67], 0
  v_mfma_f32_16x16x32_bf16 v[36:39], v[144:147], v[60:63], 0
  v_mfma_f32_16x16x32_bf16 v[40:43], v[144:147], v[64:67], 0
  v_add_f32 v68, v44, v50
  v_add_f32 v69, v45, v51
  v_add_f32 v70, v52, v58
  v_add_f32 v71, v53, v59
  v_add_f32_dpp v19, v69, v68 row_ror:8 row_mask:0xf bank_mask:0x3
  s_nop 1
  v_add_f32_dpp v19, v70, v71 row_ror:8 row_mask:0xf bank_mask:0xc
  s_waitcnt vmcnt(26)
  ds_read_b128 v[148:151], v4 offset:3072
  s_waitcnt vmcnt(25)
  ds_read_b128 v[152:155], v4 offset:4096
  s_waitcnt vmcnt(24)
  ds_read_b128 v[156:159], v4 offset:5120
  s_waitcnt vmcnt(23)
  ds_read_b128 v[160:163], v4 offset:6144
  s_waitcnt vmcnt(22)
  ds_read_b128 v[164:167], v4 offset:7168
  s_waitcnt vmcnt(21)
  ds_read_b128 v[136:139], v4 offset:8192
  s_waitcnt vmcnt(20)
  ds_read_b128 v[140:143], v4 offset:9216
  s_waitcnt vmcnt(19)
  ds_read_b128 v[144:147], v4 offset:10240
  s_waitcnt lgkmcnt(0)
  v_mfma_f32_16x16x32_bf16 v[44:47], v[148:151], v[60:63], 0
  v_mfma_f32_16x16x32_bf16 v[48:51], v[148:151], v[64:67], 0
  v_mfma_f32_16x16x32_bf16 v[52:55], v[152:155], v[60:63], 0
  v_mfma_f32_16x16x32_bf16 v[56:59], v[152:155], v[64:67], 0
  v_add_f32 v68, v28, v34
  v_add_f32 v69, v29, v35
  v_add_f32 v70, v36, v42
  v_add_f32 v71, v37, v43
  v_add_f32_dpp v20, v69, v68 row_ror:8 row_mask:0xf bank_mask:0x3
  s_nop 1
  v_add_f32_dpp v20, v70, v71 row_ror:8 row_mask:0xf bank_mask:0xc
  s_waitcnt vmcnt(18)
  ds_read_b128 v[148:151], v4 offset:11264
  s_waitcnt vmcnt(17)
  ds_read_b128 v[152:155], v4 offset:12288
  s_waitcnt lgkmcnt(0)
  v_mfma_f32_16x16x32_bf16 v[28:31], v[156:159], v[60:63], 0
  v_mfma_f32_16x16x32_bf16 v[32:35], v[156:159], v[64:67], 0
  v_mfma_f32_16x16x32_bf16 v[36:39], v[160:163], v[60:63], 0
  v_mfma_f32_16x16x32_bf16 v[40:43], v[160:163], v[64:67], 0
  v_add_f32 v68, v44, v50
  v_add_f32 v69, v45, v51
  v_add_f32 v70, v52, v58
  v_add_f32 v71, v53, v59
  v_add_f32_dpp v21, v69, v68 row_ror:8 row_mask:0xf bank_mask:0x3
  s_nop 1
  v_add_f32_dpp v21, v70, v71 row_ror:8 row_mask:0xf bank_mask:0xc
  s_waitcnt vmcnt(16)
  ds_read_b128 v[156:159], v4 offset:13312
  s_waitcnt vmcnt(15)
  ds_read_b128 v[160:163], v4 offset:14336
  s_waitcnt lgkmcnt(0)
  v_mfma_f32_16x16x32_bf16 v[44:47], v[164:167], v[60:63], 0
  v_mfma_f32_16x16x32_bf16 v[48:51], v[164:167], v[64:67], 0
  v_mfma_f32_16x16x32_bf16 v[52:55], v[136:139], v[60:63], 0
  v_mfma_f32_16x16x32_bf16 v[56:59], v[136:139], v[64:67], 0
  v_add_f32 v68, v28, v34
  v_add_f32 v69, v29, v35
  v_add_f32 v70, v36, v42
  v_add_f32 v71, v37, v43
  v_add_f32_dpp v22, v69, v68 row_ror:8 row_mask:0xf bank_mask:0x3
  s_nop 1
  v_add_f32_dpp v22, v70, v71 row_ror:8 row_mask:0xf bank_mask:0xc
  s_add_u32 s64, s7, 0x28000
  s_waitcnt vmcnt(7)
  buffer_load_dwordx4 v[164:167], v2, s[12:15], s64 offen offset:1024 nt
  s_add_u32 s64, s7, 0x28000
  s_waitcnt vmcnt(7)
  buffer_load_dwordx4 v[136:139], v2, s[12:15], s64 offen offset:2048 nt
  v_add_f32 v68, v44, v50
  v_add_f32 v69, v45, v51
  v_add_f32 v70, v52, v58
  v_add_f32 v71, v53, v59
  v_add_f32_dpp v23, v69, v68 row_ror:8 row_mask:0xf bank_mask:0x3
  s_nop 1
  v_add_f32_dpp v23, v70, v71 row_ror:8 row_mask:0xf bank_mask:0xc
  v_cvt_pk_bf16_f32 v28, v8, v9
  v_lshlrev_b32 v8, 16, v28
  v_and_b32 v9, 0xffff0000, v28
  v_mul_f32 v8, s78, v8
  v_mul_f32 v9, s78, v9
  v_cvt_pk_bf16_f32 v28, v8, v9
  v_lshlrev_b32 v8, 16, v28
  v_and_b32 v9, 0xffff0000, v28
  v_cvt_pk_bf16_f32 v29, v10, v11
  v_lshlrev_b32 v10, 16, v29
  v_and_b32 v11, 0xffff0000, v29
  v_mul_f32 v10, s78, v10
  v_mul_f32 v11, s78, v11
  v_cvt_pk_bf16_f32 v29, v10, v11
  v_lshlrev_b32 v10, 16, v29
  v_and_b32 v11, 0xffff0000, v29
  v_cvt_pk_bf16_f32 v30, v12, v13
  v_lshlrev_b32 v12, 16, v30
  v_and_b32 v13, 0xffff0000, v30
  v_mul_f32 v12, s78, v12
  v_mul_f32 v13, s78, v13
  v_cvt_pk_bf16_f32 v30, v12, v13
  v_lshlrev_b32 v12, 16, v30
  v_and_b32 v13, 0xffff0000, v30
  v_cvt_pk_bf16_f32 v31, v14, v15
  v_lshlrev_b32 v14, 16, v31
  v_and_b32 v15, 0xffff0000, v31
  v_mul_f32 v14, s78, v14
  v_mul_f32 v15, s78, v15
  v_cvt_pk_bf16_f32 v31, v14, v15
  v_lshlrev_b32 v14, 16, v31
  v_and_b32 v15, 0xffff0000, v31
  v_cvt_pk_bf16_f32 v32, v16, v17
  v_lshlrev_b32 v16, 16, v32
  v_and_b32 v17, 0xffff0000, v32
  v_mul_f32 v16, s78, v16
  v_mul_f32 v17, s78, v17
  v_cvt_pk_bf16_f32 v32, v16, v17
  v_lshlrev_b32 v16, 16, v32
  v_and_b32 v17, 0xffff0000, v32
  v_cvt_pk_bf16_f32 v33, v18, v19
  v_lshlrev_b32 v18, 16, v33
  v_and_b32 v19, 0xffff0000, v33
  v_mul_f32 v18, s78, v18
  v_mul_f32 v19, s78, v19
  v_cvt_pk_bf16_f32 v33, v18, v19
  v_lshlrev_b32 v18, 16, v33
  v_and_b32 v19, 0xffff0000, v33
  v_cvt_pk_bf16_f32 v34, v20, v21
  v_lshlrev_b32 v20, 16, v34
  v_and_b32 v21, 0xffff0000, v34
  v_mul_f32 v20, s78, v20
  v_mul_f32 v21, s78, v21
  v_cvt_pk_bf16_f32 v34, v20, v21
  v_lshlrev_b32 v20, 16, v34
  v_and_b32 v21, 0xffff0000, v34
  v_cvt_pk_bf16_f32 v35, v22, v23
  v_lshlrev_b32 v22, 16, v35
  v_and_b32 v23, 0xffff0000, v35
  v_mul_f32 v22, s78, v22
  v_mul_f32 v23, s78, v23
  v_cvt_pk_bf16_f32 v35, v22, v23
  v_lshlrev_b32 v22, 16, v35
  v_and_b32 v23, 0xffff0000, v35
  v_max3_f32 v6, v8, v9, v10
  v_max3_f32 v6, v6, v11, v12
  v_max3_f32 v6, v6, v13, v14
  v_max3_f32 v6, v6, v15, v16
  v_max3_f32 v6, v6, v17, v18
  v_max3_f32 v6, v6, v19, v20
  v_max3_f32 v6, v6, v21, v22
  v_max_f32 v6, v6, v23
  s_nop 1
  v_max_f32_dpp v6, v6, v6 row_ror:8 row_mask:0xf bank_mask:0xf
  v_mov_b32 v5, v6
  s_nop 1
  v_permlane16_swap_b32 v6, v5
  v_max_f32 v6, v6, v5
  v_mov_b32 v5, v6
  s_nop 1
  v_permlane32_swap_b32 v6, v5
  v_max_f32 v6, v6, v5
  v_mul_f32 v5, s79, v6
  v_fma_f32 v8, v8, s79, -v5
  v_fma_f32 v9, v9, s79, -v5
  v_fma_f32 v10, v10, s79, -v5
  v_fma_f32 v11, v11, s79, -v5
  v_fma_f32 v12, v12, s79, -v5
  v_fma_f32 v13, v13, s79, -v5
  v_fma_f32 v14, v14, s79, -v5
  v_fma_f32 v15, v15, s79, -v5
  v_fma_f32 v16, v16, s79, -v5
  v_fma_f32 v17, v17, s79, -v5
  v_fma_f32 v18, v18, s79, -v5
  v_fma_f32 v19, v19, s79, -v5
  v_fma_f32 v20, v20, s79, -v5
  v_fma_f32 v21, v21, s79, -v5
  v_fma_f32 v22, v22, s79, -v5
  v_fma_f32 v23, v23, s79, -v5
  v_exp_f32 v8, v8
  v_exp_f32 v9, v9
  v_exp_f32 v10, v10
  v_exp_f32 v11, v11
  v_exp_f32 v12, v12
  v_exp_f32 v13, v13
  v_exp_f32 v14, v14
  v_exp_f32 v15, v15
  v_exp_f32 v16, v16
  v_exp_f32 v17, v17
  v_exp_f32 v18, v18
  v_exp_f32 v19, v19
  v_exp_f32 v20, v20
  v_exp_f32 v21, v21
  v_exp_f32 v22, v22
  v_exp_f32 v23, v23
  v_add_f32 v7, v8, v9
  v_add_f32 v7, v7, v10
  v_add_f32 v7, v7, v11
  v_add_f32 v7, v7, v12
  v_add_f32 v7, v7, v13
  v_add_f32 v7, v7, v14
  v_add_f32 v7, v7, v15
  v_add_f32 v7, v7, v16
  v_add_f32 v7, v7, v17
  v_add_f32 v7, v7, v18
  v_add_f32 v7, v7, v19
  v_add_f32 v7, v7, v20
  v_add_f32 v7, v7, v21
  v_add_f32 v7, v7, v22
  v_add_f32 v7, v7, v23
  v_cvt_pk_bf16_f32 v8, v8, v9
  v_cvt_pk_bf16_f32 v9, v10, v11
  v_cvt_pk_bf16_f32 v12, v12, v13
  v_cvt_pk_bf16_f32 v13, v14, v15
  v_cvt_pk_bf16_f32 v16, v16, v17
  v_cvt_pk_bf16_f32 v17, v18, v19
  v_cvt_pk_bf16_f32 v20, v20, v21
  v_cvt_pk_bf16_f32 v21, v22, v23
  v_mov_b32_dpp v10, v8 row_ror:8 row_mask:0xf bank_mask:0xf
  v_mov_b32_dpp v11, v9 row_ror:8 row_mask:0xf bank_mask:0xf
  v_mov_b32_dpp v14, v12 row_ror:8 row_mask:0xf bank_mask:0xf
  v_mov_b32_dpp v15, v13 row_ror:8 row_mask:0xf bank_mask:0xf
  v_mov_b32_dpp v18, v16 row_ror:8 row_mask:0xf bank_mask:0xf
  v_mov_b32_dpp v19, v17 row_ror:8 row_mask:0xf bank_mask:0xf
  v_mov_b32_dpp v22, v20 row_ror:8 row_mask:0xf bank_mask:0xf
  v_mov_b32_dpp v23, v21 row_ror:8 row_mask:0xf bank_mask:0xf
  v_add_f32_dpp v7, v7, v7 row_ror:8 row_mask:0xf bank_mask:0xf
  v_mov_b32 v5, v7
  s_nop 1
  v_permlane16_swap_b32 v7, v5
  v_add_f32 v7, v7, v5
  v_mov_b32 v5, v7
  s_nop 1
  v_permlane32_swap_b32 v7, v5
  v_add_f32 v7, v7, v5
  s_waitcnt vmcnt(15)
  v_perm_b32 v60, v148, v140, s62
  v_perm_b32 v61, v76, v156, s62
  v_perm_b32 v62, v152, v144, s62
  v_perm_b32 v63, v80, v160, s62
  v_perm_b32 v64, v148, v140, s63
  v_perm_b32 v65, v76, v156, s63
  v_perm_b32 v66, v152, v144, s63
  v_perm_b32 v67, v80, v160, s63
  v_perm_b32 v68, v149, v141, s62
  v_perm_b32 v69, v77, v157, s62
  v_perm_b32 v70, v153, v145, s62
  v_perm_b32 v71, v81, v161, s62
  v_perm_b32 v72, v149, v141, s63
  v_perm_b32 v73, v77, v157, s63
  v_perm_b32 v74, v153, v145, s63
  v_perm_b32 v75, v81, v161, s63
  v_mfma_f32_16x16x32_bf16 v[28:31], v[60:63], v[8:11], 0
  v_mfma_f32_16x16x32_bf16 v[32:35], v[64:67], v[8:11], 0
  v_mfma_f32_16x16x32_bf16 v[36:39], v[68:71], v[8:11], 0
  v_mfma_f32_16x16x32_bf16 v[40:43], v[72:75], v[8:11], 0
  v_perm_b32 v60, v150, v142, s62
  v_perm_b32 v61, v78, v158, s62
  v_perm_b32 v62, v154, v146, s62
  v_perm_b32 v63, v82, v162, s62
  v_perm_b32 v64, v150, v142, s63
  v_perm_b32 v65, v78, v158, s63
  v_perm_b32 v66, v154, v146, s63
  v_perm_b32 v67, v82, v162, s63
  v_perm_b32 v68, v151, v143, s62
  v_perm_b32 v69, v79, v159, s62
  v_perm_b32 v70, v155, v147, s62
  v_perm_b32 v71, v83, v163, s62
  v_perm_b32 v72, v151, v143, s63
  v_perm_b32 v73, v79, v159, s63
  v_perm_b32 v74, v155, v147, s63
  v_perm_b32 v75, v83, v163, s63
  v_mfma_f32_16x16x32_bf16 v[44:47], v[60:63], v[8:11], 0
  v_mfma_f32_16x16x32_bf16 v[48:51], v[64:67], v[8:11], 0
  v_mfma_f32_16x16x32_bf16 v[52:55], v[68:71], v[8:11], 0
  v_mfma_f32_16x16x32_bf16 v[56:59], v[72:75], v[8:11], 0
  s_add_u32 s64, s7, 0x28000
  s_waitcnt vmcnt(7)
  buffer_load_dwordx4 v[140:143], v2, s[12:15], s64 offen offset:3072 nt
  s_add_u32 s64, s28, 0x0
  s_waitcnt vmcnt(7)
  buffer_load_dwordx4 v[144:147], v2, s[12:15], s64 offen offset:0 nt
  s_add_u32 s64, s28, 0x0
  s_waitcnt vmcnt(7)
  buffer_load_dwordx4 v[148:151], v2, s[12:15], s64 offen offset:1024 nt
  s_add_u32 s64, s28, 0x0
  s_waitcnt vmcnt(7)
  buffer_load_dwordx4 v[152:155], v2, s[12:15], s64 offen offset:2048 nt
  s_add_u32 s64, s28, 0x0
  s_waitcnt vmcnt(7)
  buffer_load_dwordx4 v[156:159], v2, s[12:15], s64 offen offset:3072 nt
  s_add_u32 s64, s100, 0x0
  s_waitcnt vmcnt(7)
  buffer_load_dwordx4 v[160:163], v2, s[12:15], s64 offen offset:0 nt
  s_add_u32 s64, s100, 0x0
  s_waitcnt vmcnt(7)
  buffer_load_dwordx4 v[76:79], v2, s[12:15], s64 offen offset:1024 nt
  s_add_u32 s64, s100, 0x0
  s_waitcnt vmcnt(7)
  buffer_load_dwordx4 v[80:83], v2, s[12:15], s64 offen offset:2048 nt
  s_waitcnt vmcnt(15)
  v_perm_b32 v60, v92, v84, s62
  v_perm_b32 v61, v108, v100, s62
  v_perm_b32 v62, v96, v88, s62
  v_perm_b32 v63, v112, v104, s62
  v_perm_b32 v64, v92, v84, s63
  v_perm_b32 v65, v108, v100, s63
  v_perm_b32 v66, v96, v88, s63
  v_perm_b32 v67, v112, v104, s63
  v_perm_b32 v68, v93, v85, s62
  v_perm_b32 v69, v109, v101, s62
  v_perm_b32 v70, v97, v89, s62
  v_perm_b32 v71, v113, v105, s62
  v_perm_b32 v72, v93, v85, s63
  v_perm_b32 v73, v109, v101, s63
  v_perm_b32 v74, v97, v89, s63
  v_perm_b32 v75, v113, v105, s63
  v_mfma_f32_16x16x32_bf16 v[28:31], v[60:63], v[12:15], v[28:31]
  v_mfma_f32_16x16x32_bf16 v[32:35], v[64:67], v[12:15], v[32:35]
  v_mfma_f32_16x16x32_bf16 v[36:39], v[68:71], v[12:15], v[36:39]
  v_mfma_f32_16x16x32_bf16 v[40:43], v[72:75], v[12:15], v[40:43]
  v_perm_b32 v60, v94, v86, s62
  v_perm_b32 v61, v110, v102, s62
  v_perm_b32 v62, v98, v90, s62
  v_perm_b32 v63, v114, v106, s62
  v_perm_b32 v64, v94, v86, s63
  v_perm_b32 v65, v110, v102, s63
  v_perm_b32 v66, v98, v90, s63
  v_perm_b32 v67, v114, v106, s63
  v_perm_b32 v68, v95, v87, s62
  v_perm_b32 v69, v111, v103, s62
  v_perm_b32 v70, v99, v91, s62
  v_perm_b32 v71, v115, v107, s62
  v_perm_b32 v72, v95, v87, s63
  v_perm_b32 v73, v111, v103, s63
  v_perm_b32 v74, v99, v91, s63
  v_perm_b32 v75, v115, v107, s63
  v_mfma_f32_16x16x32_bf16 v[44:47], v[60:63], v[12:15], v[44:47]
  v_mfma_f32_16x16x32_bf16 v[48:51], v[64:67], v[12:15], v[48:51]
  v_mfma_f32_16x16x32_bf16 v[52:55], v[68:71], v[12:15], v[52:55]
  v_mfma_f32_16x16x32_bf16 v[56:59], v[72:75], v[12:15], v[56:59]
  s_add_u32 s64, s100, 0x0
  s_waitcnt vmcnt(7)
  buffer_load_dwordx4 v[84:87], v2, s[12:15], s64 offen offset:3072 nt
  s_waitcnt vmcnt(8)
  v_perm_b32 v60, v124, v116, s62
  v_perm_b32 v61, v136, v132, s62
  v_perm_b32 v62, v128, v120, s62
  v_perm_b32 v63, v140, v164, s62
  v_perm_b32 v64, v124, v116, s63
  v_perm_b32 v65, v136, v132, s63
  v_perm_b32 v66, v128, v120, s63
  v_perm_b32 v67, v140, v164, s63
  v_perm_b32 v68, v125, v117, s62
  v_perm_b32 v69, v137, v133, s62
  v_perm_b32 v70, v129, v121, s62
  v_perm_b32 v71, v141, v165, s62
  v_perm_b32 v72, v125, v117, s63
  v_perm_b32 v73, v137, v133, s63
  v_perm_b32 v74, v129, v121, s63
  v_perm_b32 v75, v141, v165, s63
  v_mfma_f32_16x16x32_bf16 v[28:31], v[60:63], v[16:19], v[28:31]
  v_mfma_f32_16x16x32_bf16 v[32:35], v[64:67], v[16:19], v[32:35]
  v_mfma_f32_16x16x32_bf16 v[36:39], v[68:71], v[16:19], v[36:39]
  v_mfma_f32_16x16x32_bf16 v[40:43], v[72:75], v[16:19], v[40:43]
  v_perm_b32 v60, v126, v118, s62
  v_perm_b32 v61, v138, v134, s62
  v_perm_b32 v62, v130, v122, s62
  v_perm_b32 v63, v142, v166, s62
  v_perm_b32 v64, v126, v118, s63
  v_perm_b32 v65, v138, v134, s63
  v_perm_b32 v66, v130, v122, s63
  v_perm_b32 v67, v142, v166, s63
  v_perm_b32 v68, v127, v119, s62
  v_perm_b32 v69, v139, v135, s62
  v_perm_b32 v70, v131, v123, s62
  v_perm_b32 v71, v143, v167, s62
  v_perm_b32 v72, v127, v119, s63
  v_perm_b32 v73, v139, v135, s63
  v_perm_b32 v74, v131, v123, s63
  v_perm_b32 v75, v143, v167, s63
  v_mfma_f32_16x16x32_bf16 v[44:47], v[60:63], v[16:19], v[44:47]
  v_mfma_f32_16x16x32_bf16 v[48:51], v[64:67], v[16:19], v[48:51]
  v_mfma_f32_16x16x32_bf16 v[52:55], v[68:71], v[16:19], v[52:55]
  v_mfma_f32_16x16x32_bf16 v[56:59], v[72:75], v[16:19], v[56:59]
  v_mov_b32 v27, -1
  s_cmp_ge_u32 s3, 2
  s_cbranch_scc1 L_tk_14
  s_lshl_b32 s101, s25, 3
  s_and_b32 s64, s3, 1
  s_add_u32 s101, s101, s64
  s_lshl_b32 s101, s101, 8
  s_add_u32 s101, s101, 0x2b0000
  v_mov_b32 v27, 1
  s_and_b64 exec, s[26:27], 0x1
  buffer_atomic_add v27, v3, s[16:19], s101 offen sc0 sc1
  s_mov_b64 exec, s[26:27]
L_tk_14:
  s_waitcnt vmcnt(0)
  v_perm_b32 v60, v152, v144, s62
  v_perm_b32 v61, v80, v160, s62
  v_perm_b32 v62, v156, v148, s62
  v_perm_b32 v63, v84, v76, s62
  v_perm_b32 v64, v152, v144, s63
  v_perm_b32 v65, v80, v160, s63
  v_perm_b32 v66, v156, v148, s63
  v_perm_b32 v67, v84, v76, s63
  v_perm_b32 v68, v153, v145, s62
  v_perm_b32 v69, v81, v161, s62
  v_perm_b32 v70, v157, v149, s62
  v_perm_b32 v71, v85, v77, s62
  v_perm_b32 v72, v153, v145, s63
  v_perm_b32 v73, v81, v161, s63
  v_perm_b32 v74, v157, v149, s63
  v_perm_b32 v75, v85, v77, s63
  v_mfma_f32_16x16x32_bf16 v[28:31], v[60:63], v[20:23], v[28:31]
  v_mfma_f32_16x16x32_bf16 v[32:35], v[64:67], v[20:23], v[32:35]
  v_mfma_f32_16x16x32_bf16 v[36:39], v[68:71], v[20:23], v[36:39]
  v_mfma_f32_16x16x32_bf16 v[40:43], v[72:75], v[20:23], v[40:43]
  v_perm_b32 v60, v154, v146, s62
  v_perm_b32 v61, v82, v162, s62
  v_perm_b32 v62, v158, v150, s62
  v_perm_b32 v63, v86, v78, s62
  v_perm_b32 v64, v154, v146, s63
  v_perm_b32 v65, v82, v162, s63
  v_perm_b32 v66, v158, v150, s63
  v_perm_b32 v67, v86, v78, s63
  v_perm_b32 v68, v155, v147, s62
  v_perm_b32 v69, v83, v163, s62
  v_perm_b32 v70, v159, v151, s62
  v_perm_b32 v71, v87, v79, s62
  v_perm_b32 v72, v155, v147, s63
  v_perm_b32 v73, v83, v163, s63
  v_perm_b32 v74, v159, v151, s63
  v_perm_b32 v75, v87, v79, s63
  v_mfma_f32_16x16x32_bf16 v[44:47], v[60:63], v[20:23], v[44:47]
  v_mfma_f32_16x16x32_bf16 v[48:51], v[64:67], v[20:23], v[48:51]
  v_mfma_f32_16x16x32_bf16 v[52:55], v[68:71], v[20:23], v[52:55]
  v_mfma_f32_16x16x32_bf16 v[56:59], v[72:75], v[20:23], v[56:59]
  s_branch L_st_dyn
L_st_n3l:
  s_lshl_b32 s80, s2, 12
  s_lshl_b32 s64, s5, 10
  s_add_u32 s80, s80, s64
  s_add_u32 s80, s80, 0x100000
  s_cmp_ge_u32 s3, 4
  s_cselect_b32 s29, 1, 0
  s_add_u32 s64, s28, 0x0
  s_waitcnt vmcnt(3)
  buffer_load_dwordx4 v[140:143], v1, s[8:11], s64 offen offset:0 nt
  s_add_u32 s64, s28, 0x0
  s_waitcnt vmcnt(3)
  buffer_load_dwordx4 v[144:147], v1, s[8:11], s64 offen offset:1024 nt
  s_add_u32 s64, s28, 0x0
  s_waitcnt vmcnt(3)
  buffer_load_dwordx4 v[148:151], v1, s[8:11], s64 offen offset:2048 nt
  s_add_u32 s64, s28, 0x0
  s_waitcnt vmcnt(3)
  buffer_load_dwordx4 v[152:155], v1, s[8:11], s64 offen offset:3072 nt
  s_add_u32 s64, s100, 0x0
  s_waitcnt vmcnt(3)
  buffer_load_dwordx4 v[156:159], v1, s[8:11], s64 offen offset:0 nt
  s_cmp_lg_u32 s29, 0
  s_cbranch_scc1 L_qi_15
  buffer_load_dwordx4 v[28:31], v2, s[16:19], s80 offen sc1
L_qi_15:
  s_add_u32 s64, s100, 0x0
  s_waitcnt vmcnt(3)
  buffer_load_dwordx4 v[160:163], v1, s[8:11], s64 offen offset:1024 nt
  s_add_u32 s64, s100, 0x0
  s_waitcnt vmcnt(3)
  buffer_load_dwordx4 v[164:167], v1, s[8:11], s64 offen offset:2048 nt
  v_mov_b32 v4, 1
  s_waitcnt lgkmcnt(0)
  s_and_b64 exec, s[26:27], 0x1
  ds_add_u32 v3, v4 offset:36
  s_mov_b64 exec, s[26:27]
  s_mul_i32 s65, s3, 15360
  s_add_u32 s65, s65, 40960
  s_add_u32 s64, s100, 0xc00
  s_add_u32 m0, s65, 0
  s_waitcnt vmcnt(3)
  buffer_load_dwordx4 v1, s[8:11], s64 offen nt lds
  s_add_u32 s64, s7, 0x0
  s_add_u32 m0, s65, 1024
  s_waitcnt vmcnt(3)
  buffer_load_dwordx4 v2, s[12:15], s64 offen nt lds
  s_add_u32 s64, s7, 0x400
  s_add_u32 m0, s65, 2048
  s_waitcnt vmcnt(3)
  buffer_load_dwordx4 v2, s[12:15], s64 offen nt lds
  s_cmp_lg_u32 s29, 0
  s_cbranch_scc1 L_qc_16
  v_cmp_eq_u32 vcc, s4, v29
  v_cmp_eq_u32 s[76:77], s4, v31
  s_nop 0
  s_and_b64 vcc, vcc, s[76:77]
  s_cmp_eq_u64 vcc, -1
  s_cbranch_scc0 L_qc_16
  v_mov_b32 v29, v30
  s_lshl_b32 s67, s5, 9
  v_lshlrev_b32 v4, 3, v0
  v_add_u32 v4, s67, v4
  ds_write_b64 v4, v[28:29] offset:256
  v_mov_b32 v4, 1
  s_waitcnt lgkmcnt(0)
  s_and_b64 exec, s[26:27], 0x1
  ds_add_u32 v3, v4 offset:0
  s_mov_b64 exec, s[26:27]
  s_mov_b32 s29, 1
L_qc_16:
  s_add_u32 s64, s7, 0x800
  s_add_u32 m0, s65, 3072
  s_waitcnt vmcnt(3)
  buffer_load_dwordx4 v2, s[12:15], s64 offen nt lds
  s_cmp_lg_u32 s29, 0
  s_cbranch_scc1 L_qi_17
  buffer_load_dwordx4 v[28:31], v2, s[16:19], s80 offen sc1
L_qi_17:
  s_add_u32 s64, s7, 0xc00
  s_add_u32 m0, s65, 4096
  s_waitcnt vmcnt(3)
  buffer_load_dwordx4 v2, s[12:15], s64 offen nt lds
  s_add_u32 s64, s7, 0x8000
  s_add_u32 m0, s65, 5120
  s_waitcnt vmcnt(3)
  buffer_load_dwordx4 v2, s[12:15], s64 offen nt lds
  s_add_u32 s64, s7, 0x8400
  s_add_u32 m0, s65, 6144
  s_waitcnt vmcnt(3)
  buffer_load_dwordx4 v2, s[12:15], s64 offen nt lds
  s_add_u32 s64, s7, 0x8800
  s_add_u32 m0, s65, 7168
  s_waitcnt vmcnt(3)
  buffer_load_dwordx4 v2, s[12:15], s64 offen nt lds
  s_add_u32 s64, s7, 0x8c00
  s_add_u32 m0, s65, 8192
  s_waitcnt vmcnt(3)
  buffer_load_dwordx4 v2, s[12:15], s64 offen nt lds
  s_cmp_lg_u32 s29, 0
  s_cbranch_scc1 L_qc_18
  v_cmp_eq_u32 vcc, s4, v29
  v_cmp_eq_u32 s[76:77], s4, v31
  s_nop 0
  s_and_b64 vcc, vcc, s[76:77]
  s_cmp_eq_u64 vcc, -1
  s_cbranch_scc0 L_qc_18
  v_mov_b32 v29, v30
  s_lshl_b32 s67, s5, 9
  v_lshlrev_b32 v4, 3, v0
  v_add_u32 v4, s67, v4
  ds_write_b64 v4, v[28:29] offset:256
  v_mov_b32 v4, 1
  s_waitcnt lgkmcnt(0)
  s_and_b64 exec, s[26:27], 0x1
  ds_add_u32 v3, v4 offset:0
  s_mov_b64 exec, s[26:27]
  s_mov_b32 s29, 1
L_qc_18:
  s_add_u32 s64, s7, 0x10000
  s_add_u32 m0, s65, 9216
  s_waitcnt vmcnt(3)
  buffer_load_dwordx4 v2, s[12:15], s64 offen nt lds
  s_cmp_lg_u32 s29, 0
  s_cbranch_scc1 L_qi_19
  buffer_load_dwordx4 v[28:31], v2, s[16:19], s80 offen sc1
L_qi_19:
  s_add_u32 s64, s7, 0x10400
  s_add_u32 m0, s65, 10240
  s_waitcnt vmcnt(3)
  buffer_load_dwordx4 v2, s[12:15], s64 offen nt lds
  s_add_u32 s64, s7, 0x10800
  s_add_u32 m0, s65, 11264
  s_waitcnt vmcnt(3)
  buffer_load_dwordx4 v2, s[12:15], s64 offen nt lds
  s_add_u32 s64, s7, 0x10c00
  s_add_u32 m0, s65, 12288
  s_waitcnt vmcnt(3)
  buffer_load_dwordx4 v2, s[12:15], s64 offen nt lds
  s_add_u32 s64, s7, 0x18000
  s_add_u32 m0, s65, 13312
  s_waitcnt vmcnt(3)
  buffer_load_dwordx4 v2, s[12:15], s64 offen nt lds
  s_add_u32 s64, s7, 0x18400
  s_add_u32 m0, s65, 14336
  s_waitcnt vmcnt(3)
  buffer_load_dwordx4 v2, s[12:15], s64 offen nt lds
  s_cmp_lg_u32 s29, 0
  s_cbranch_scc1 L_qc_20
  v_cmp_eq_u32 vcc, s4, v29
  v_cmp_eq_u32 s[76:77], s4, v31
  s_nop 0
  s_and_b64 vcc, vcc, s[76:77]
  s_cmp_eq_u64 vcc, -1
  s_cbranch_scc0 L_qc_20
  v_mov_b32 v29, v30
  s_lshl_b32 s67, s5, 9
  v_lshlrev_b32 v4, 3, v0
  v_add_u32 v4, s67, v4
  ds_write_b64 v4, v[28:29] offset:256
  v_mov_b32 v4, 1
  s_waitcnt lgkmcnt(0)
  s_and_b64 exec, s[26:27], 0x1
  ds_add_u32 v3, v4 offset:0
  s_mov_b64 exec, s[26:27]
  s_mov_b32 s29, 1
L_qc_20:
  s_cmp_lg_u32 s29, 0
  s_cbranch_scc1 L_st_qwb
  s_lshl_b32 s80, s2, 12
  s_lshl_b32 s64, s5, 10
  s_add_u32 s80, s80, s64
  s_add_u32 s80, s80, 0x100000
  s_mov_b32 s68, 0
L_p_21:
  s_add_u32 s68, s68, 1
  s_cmp_gt_u32 s68, 0x40000
  s_cbranch_scc1 L_fail
  s_cbranch_execz L_ps_22
  buffer_load_dwordx4 v[28:31], v2, s[16:19], s80 offen offset:0 sc1
  s_waitcnt vmcnt(0)
L_ps_22:
  s_mov_b64 s[70:71], -1
  v_cmp_eq_u32 vcc, s4, v29
  v_cmp_eq_u32 s[76:77], s4, v31
  s_and_b64 s[70:71], s[70:71], vcc
  s_and_b64 s[70:71], s[70:71], s[76:77]
  s_cmp_eq_u64 s[70:71], -1
  s_cbranch_execz L_pd_23
  s_cbranch_scc1 L_pd_23
  s_sleep 16
  s_branch L_p_21
L_pd_23:
  v_mov_b32 v29, v30
  s_lshl_b32 s67, s5, 9
  v_lshlrev_b32 v4, 3, v0
  v_add_u32 v4, s67, v4
  ds_write_b64 v4, v[28:29] offset:256
  v_mov_b32 v4, 1
  s_waitcnt lgkmcnt(0)
  s_and_b64 exec, s[26:27], 0x1
  ds_add_u32 v3, v4 offset:0
  s_mov_b64 exec, s[26:27]
L_st_qwb:
  s_mov_b32 s68, 0
L_w_24:
  s_sleep 2
  s_add_u32 s68, s68, 1
  s_cmp_gt_u32 s68, 0x400000
  s_cbranch_scc1 L_fail
  ds_read_b32 v4, v3 offset:0
  s_waitcnt lgkmcnt(0)
  v_readfirstlane_b32 s67, v4
  s_nop 0
  s_cmp_ge_u32 s67, 4
  s_cbranch_execz L_wd_25
  s_cbranch_scc0 L_w_24
L_wd_25:
  ds_read_b128 v[60:63], v5 offset:256
  ds_read_b128 v[64:67], v5 offset:288
  s_mul_i32 s65, s3, 15360
  s_add_u32 s65, s65, 40960
  v_add_u32 v4, s65, v2
  s_waitcnt lgkmcnt(0)
  s_waitcnt vmcnt(36)
  v_mfma_f32_16x16x32_bf16 v[28:31], v[76:79], v[60:63], 0
  v_mfma_f32_16x16x32_bf16 v[32:35], v[76:79], v[64:67], 0
  v_mfma_f32_16x16x32_bf16 v[36:39], v[80:83], v[60:63], 0
  v_mfma_f32_16x16x32_bf16 v[40:43], v[80:83], v[64:67], 0
  s_add_u32 s64, s7, 0x18000
  s_waitcnt vmcnt(7)
  buffer_load_dwordx4 v[76:79], v2, s[12:15], s64 offen offset:2048 nt
  s_waitcnt vmcnt(35)
  v_mfma_f32_16x16x32_bf16 v[44:47], v[84:87], v[60:63], 0
  v_mfma_f32_16x16x32_bf16 v[48:51], v[84:87], v[64:67], 0
  v_mfma_f32_16x16x32_bf16 v[52:55], v[88:91], v[60:63], 0
  v_mfma_f32_16x16x32_bf16 v[56:59], v[88:91], v[64:67], 0
  v_add_f32 v68, v28, v34
  v_add_f32 v69, v29, v35
  v_add_f32 v70, v36, v42
  v_add_f32 v71, v37, v43
  v_add_f32_dpp v8, v69, v68 row_ror:8 row_mask:0xf bank_mask:0x3
  s_nop 1
  v_add_f32_dpp v8, v70, v71 row_ror:8 row_mask:0xf bank_mask:0xc
  s_add_u32 s64, s7, 0x18000
  s_waitcnt vmcnt(7)
  buffer_load_dwordx4 v[80:83], v2, s[12:15], s64 offen offset:3072 nt
  s_add_u32 s64, s28, 0x0
  s_waitcnt vmcnt(7)
  buffer_load_dwordx4 v[84:87], v2, s[12:15], s64 offen offset:0 nt
  s_waitcnt vmcnt(35)
  v_mfma_f32_16x16x32_bf16 v[28:31], v[92:95], v[60:63], 0
  v_mfma_f32_16x16x32_bf16 v[32:35], v[92:95], v[64:67], 0
  v_mfma_f32_16x16x32_bf16 v[36:39], v[96:99], v[60:63], 0
  v_mfma_f32_16x16x32_bf16 v[40:43], v[96:99], v[64:67], 0
  v_add_f32 v68, v44, v50
  v_add_f32 v69, v45, v51
  v_add_f32 v70, v52, v58
  v_add_f32 v71, v53, v59
  v_add_f32_dpp v9, v69, v68 row_ror:8 row_mask:0xf bank_mask:0x3
  s_nop 1
  v_add_f32_dpp v9, v70, v71 row_ror:8 row_mask:0xf bank_mask:0xc
  s_add_u32 s64, s28, 0x0
  s_waitcnt vmcnt(7)
  buffer_load_dwordx4 v[88:91], v2, s[12:15], s64 offen offset:1024 nt
  s_add_u32 s64, s28, 0x0
  s_waitcnt vmcnt(7)
  buffer_load_dwordx4 v[92:95], v2, s[12:15], s64 offen offset:2048 nt
  s_waitcnt vmcnt(35)
  v_mfma_f32_16x16x32_bf16 v[44:47], v[100:103], v[60:63], 0
  v_mfma_f32_16x16x32_bf16 v[48:51], v[100:103], v[64:67], 0
  v_mfma_f32_16x16x32_bf16 v[52:55], v[104:107], v[60:63], 0
  v_mfma_f32_16x16x32_bf16 v[56:59], v[104:107], v[64:67], 0
  v_add_f32 v68, v28, v34
  v_add_f32 v69, v29, v35
  v_add_f32 v70, v36, v42
  v_add_f32 v71, v37, v43
  v_add_f32_dpp v10, v69, v68 row_ror:8 row_mask:0xf bank_mask:0x3
  s_nop 1
  v_add_f32_dpp v10, v70, v71 row_ror:8 row_mask:0xf bank_mask:0xc
  s_add_u32 s64, s28, 0x0
  s_waitcnt vmcnt(7)
  buffer_load_dwordx4 v[96:99], v2, s[12:15], s64 offen offset:3072 nt
  s_add_u32 s64, s100, 0x0
  s_waitcnt vmcnt(7)
  buffer_load_dwordx4 v[100:103], v2, s[12:15], s64 offen offset:0 nt
  s_waitcnt vmcnt(35)
  v_mfma_f32_16x16x32_bf16 v[28:31], v[108:111], v[60:63], 0
  v_mfma_f32_16x16x32_bf16 v[32:35], v[108:111], v[64:67], 0
  v_mfma_f32_16x16x32_bf16 v[36:39], v[112:115], v[60:63], 0
  v_mfma_f32_16x16x32_bf16 v[40:43], v[112:115], v[64:67], 0
  v_add_f32 v68, v44, v50
  v_add_f32 v69, v45, v51
  v_add_f32 v70, v52, v58
  v_add_f32 v71, v53, v59
  v_add_f32_dpp v11, v69, v68 row_ror:8 row_mask:0xf bank_mask:0x3
  s_nop 1
  v_add_f32_dpp v11, v70, v71 row_ror:8 row_mask:0xf bank_mask:0xc
  s_add_u32 s64, s100, 0x0
  s_waitcnt vmcnt(7)
  buffer_load_dwordx4 v[104:107], v2, s[12:15], s64 offen offset:1024 nt
  s_waitcnt vmcnt(34)
  v_mfma_f32_16x16x32_bf16 v[44:47], v[116:119], v[60:63], 0
  v_mfma_f32_16x16x32_bf16 v[48:51], v[116:119], v[64:67], 0
  v_mfma_f32_16x16x32_bf16 v[52:55], v[120:123], v[60:63], 0
  v_mfma_f32_16x16x32_bf16 v[56:59], v[120:123], v[64:67], 0
  v_add_f32 v68, v28, v34
  v_add_f32 v69, v29, v35
  v_add_f32 v70, v36, v42
  v_add_f32 v71, v37, v43
  v_add_f32_dpp v12, v69, v68 row_ror:8 row_mask:0xf bank_mask:0x3
  s_nop 1
  v_add_f32_dpp v12, v70, v71 row_ror:8 row_mask:0xf bank_mask:0xc
  s_waitcnt vmcnt(32)
  v_mfma_f32_16x16x32_bf16 v[28:31], v[124:127], v[60:63], 0
  v_mfma_f32_16x16x32_bf16 v[32:35], v[124:127], v[64:67], 0
  v_mfma_f32_16x16x32_bf16 v[36:39], v[128:131], v[60:63], 0
  v_mfma_f32_16x16x32_bf16 v[40:43], v[128:131], v[64:67], 0
  v_add_f32 v68, v44, v50
  v_add_f32 v69, v45, v51
  v_add_f32 v70, v52, v58
  v_add_f32 v71, v53, v59
  v_add_f32_dpp v13, v69, v68 row_ror:8 row_mask:0xf bank_mask:0x3
  s_nop 1
  v_add_f32_dpp v13, v70, v71 row_ror:8 row_mask:0xf bank_mask:0xc
  s_waitcnt vmcnt(30)
  v_mfma_f32_16x16x32_bf16 v[44:47], v[132:135], v[60:63], 0
  v_mfma_f32_16x16x32_bf16 v[48:51], v[132:135], v[64:67], 0
  v_mfma_f32_16x16x32_bf16 v[52:55], v[136:139], v[60:63], 0
  v_mfma_f32_16x16x32_bf16 v[56:59], v[136:139], v[64:67], 0
  v_add_f32 v68, v28, v34
  v_add_f32 v69, v29, v35
  v_add_f32 v70, v36, v42
  v_add_f32 v71, v37, v43
  v_add_f32_dpp v14, v69, v68 row_ror:8 row_mask:0xf bank_mask:0x3
  s_nop 1
  v_add_f32_dpp v14, v70, v71 row_ror:8 row_mask:0xf bank_mask:0xc
  s_waitcnt vmcnt(28)
  v_mfma_f32_16x16x32_bf16 v[28:31], v[140:143], v[60:63], 0
  v_mfma_f32_16x16x32_bf16 v[32:35], v[140:143], v[64:67], 0
  v_mfma_f32_16x16x32_bf16 v[36:39], v[144:147], v[60:63], 0
  v_mfma_f32_16x16x32_bf16 v[40:43], v[144:147], v[64:67], 0
  v_add_f32 v68, v44, v50
  v_add_f32 v69, v45, v51
  v_add_f32 v70, v52, v58
  v_add_f32 v71, v53, v59
  v_add_f32_dpp v15, v69, v68 row_ror:8 row_mask:0xf bank_mask:0x3
  s_nop 1
  v_add_f32_dpp v15, v70, v71 row_ror:8 row_mask:0xf bank_mask:0xc
  s_waitcnt vmcnt(22)
  ds_read_b128 v[108:111], v4 offset:0
  s_waitcnt vmcnt(21)
  ds_read_b128 v[112:115], v4 offset:1024
  s_waitcnt vmcnt(20)
  ds_read_b128 v[116:119], v4 offset:2048
  s_add_u32 s64, s100, 0x0
  s_waitcnt vmcnt(7)
  buffer_load_dwordx4 v[120:123], v2, s[12:15], s64 offen offset:2048 nt
  s_waitcnt vmcnt(27)
  v_mfma_f32_16x16x32_bf16 v[44:47], v[148:151], v[60:63], 0
  v_mfma_f32_16x16x32_bf16 v[48:51], v[148:151], v[64:67], 0
  v_mfma_f32_16x16x32_bf16 v[52:55], v[152:155], v[60:63], 0
  v_mfma_f32_16x16x32_bf16 v[56:59], v[152:155], v[64:67], 0
  v_add_f32 v68, v28, v34
  v_add_f32 v69, v29, v35
  v_add_f32 v70, v36, v42
  v_add_f32 v71, v37, v43
  v_add_f32_dpp v16, v69, v68 row_ror:8 row_mask:0xf bank_mask:0x3
  s_nop 1
  v_add_f32_dpp v16, v70, v71 row_ror:8 row_mask:0xf bank_mask:0xc
  s_waitcnt vmcnt(20)
  ds_read_b128 v[124:127], v4 offset:3072
  s_waitcnt vmcnt(19)
  ds_read_b128 v[128:131], v4 offset:4096
  s_waitcnt vmcnt(25)
  v_mfma_f32_16x16x32_bf16 v[28:31], v[156:159], v[60:63], 0
  v_mfma_f32_16x16x32_bf16 v[32:35], v[156:159], v[64:67], 0
  v_mfma_f32_16x16x32_bf16 v[36:39], v[160:163], v[60:63], 0
  v_mfma_f32_16x16x32_bf16 v[40:43], v[160:163], v[64:67], 0
  v_add_f32 v68, v44, v50
  v_add_f32 v69, v45, v51
  v_add_f32 v70, v52, v58
  v_add_f32 v71, v53, v59
  v_add_f32_dpp v17, v69, v68 row_ror:8 row_mask:0xf bank_mask:0x3
  s_nop 1
  v_add_f32_dpp v17, v70, v71 row_ror:8 row_mask:0xf bank_mask:0xc
  s_waitcnt vmcnt(18)
  ds_read_b128 v[132:135], v4 offset:5120
  s_waitcnt vmcnt(17)
  ds_read_b128 v[136:139], v4 offset:6144
  s_waitcnt vmcnt(24)
  s_waitcnt lgkmcnt(0)
  v_mfma_f32_16x16x32_bf16 v[44:47], v[164:167], v[60:63], 0
  v_mfma_f32_16x16x32_bf16 v[48:51], v[164:167], v[64:67], 0
  v_mfma_f32_16x16x32_bf16 v[52:55], v[108:111], v[60:63], 0
  v_mfma_f32_16x16x32_bf16 v[56:59], v[108:111], v[64:67], 0
  v_add_f32 v68, v28, v34
  v_add_f32 v69, v29, v35
  v_add_f32 v70, v36, v42
  v_add_f32 v71, v37, v43
  v_add_f32_dpp v18, v69, v68 row_ror:8 row_mask:0xf bank_mask:0x3
  s_nop 1
  v_add_f32_dpp v18, v70, v71 row_ror:8 row_mask:0xf bank_mask:0xc
  s_waitcnt vmcnt(16)
  ds_read_b128 v[140:143], v4 offset:7168
  s_waitcnt vmcnt(15)
  ds_read_b128 v[144:147], v4 offset:8192
  v_add_f32 v68, v44, v50
  v_add_f32 v69, v45, v51
  v_add_f32 v70, v52, v58
  v_add_f32 v71, v53, v59
  v_add_f32_dpp v19, v69, v68 row_ror:8 row_mask:0xf bank_mask:0x3
  s_nop 1
  v_add_f32_dpp v19, v70, v71 row_ror:8 row_mask:0xf bank_mask:0xc
  v_cvt_pk_bf16_f32 v28, v8, v9
  v_lshlrev_b32 v8, 16, v28
  v_and_b32 v9, 0xffff0000, v28
  v_mul_f32 v8, s78, v8
  v_mul_f32 v9, s78, v9
  v_cvt_pk_bf16_f32 v28, v8, v9
  v_lshlrev_b32 v8, 16, v28
  v_and_b32 v9, 0xffff0000, v28
  v_cvt_pk_bf16_f32 v29, v10, v11
  v_lshlrev_b32 v10, 16, v29
  v_and_b32 v11, 0xffff0000, v29
  v_mul_f32 v10, s78, v10
  v_mul_f32 v11, s78, v11
  v_cvt_pk_bf16_f32 v29, v10, v11
  v_lshlrev_b32 v10, 16, v29
  v_and_b32 v11, 0xffff0000, v29
  v_cvt_pk_bf16_f32 v30, v12, v13
  v_lshlrev_b32 v12, 16, v30
  v_and_b32 v13, 0xffff0000, v30
  v_mul_f32 v12, s78, v12
  v_mul_f32 v13, s78, v13
  v_cvt_pk_bf16_f32 v30, v12, v13
  v_lshlrev_b32 v12, 16, v30
  v_and_b32 v13, 0xffff0000, v30
  v_cvt_pk_bf16_f32 v31, v14, v15
  v_lshlrev_b32 v14, 16, v31
  v_and_b32 v15, 0xffff0000, v31
  v_mul_f32 v14, s78, v14
  v_mul_f32 v15, s78, v15
  v_cvt_pk_bf16_f32 v31, v14, v15
  v_lshlrev_b32 v14, 16, v31
  v_and_b32 v15, 0xffff0000, v31
  v_cvt_pk_bf16_f32 v32, v16, v17
  v_lshlrev_b32 v16, 16, v32
  v_and_b32 v17, 0xffff0000, v32
  v_mul_f32 v16, s78, v16
  v_mul_f32 v17, s78, v17
  v_cvt_pk_bf16_f32 v32, v16, v17
  v_lshlrev_b32 v16, 16, v32
  v_and_b32 v17, 0xffff0000, v32
  v_cvt_pk_bf16_f32 v33, v18, v19
  v_lshlrev_b32 v18, 16, v33
  v_and_b32 v19, 0xffff0000, v33
  v_mul_f32 v18, s78, v18
  v_mul_f32 v19, s78, v19
  v_cvt_pk_bf16_f32 v33, v18, v19
  v_lshlrev_b32 v18, 16, v33
  v_and_b32 v19, 0xffff0000, v33
  v_max3_f32 v6, v8, v9, v10
  v_max3_f32 v6, v6, v11, v12
  v_max3_f32 v6, v6, v13, v14
  v_max3_f32 v6, v6, v15, v16
  v_max3_f32 v6, v6, v17, v18
  v_max_f32 v6, v6, v19
  s_nop 1
  v_max_f32_dpp v6, v6, v6 row_ror:8 row_mask:0xf bank_mask:0xf
  v_mov_b32 v5, v6
  s_nop 1
  v_permlane16_swap_b32 v6, v5
  v_max_f32 v6, v6, v5
  v_mov_b32 v5, v6
  s_nop 1
  v_permlane32_swap_b32 v6, v5
  v_max_f32 v6, v6, v5
  v_mul_f32 v5, s79, v6
  v_fma_f32 v8, v8, s79, -v5
  v_fma_f32 v9, v9, s79, -v5
  v_fma_f32 v10, v10, s79, -v5
  v_fma_f32 v11, v11, s79, -v5
  v_fma_f32 v12, v12, s79, -v5
  v_fma_f32 v13, v13, s79, -v5
  v_fma_f32 v14, v14, s79, -v5
  v_fma_f32 v15, v15, s79, -v5
  v_fma_f32 v16, v16, s79, -v5
  v_fma_f32 v17, v17, s79, -v5
  v_fma_f32 v18, v18, s79, -v5
  v_fma_f32 v19, v19, s79, -v5
  v_exp_f32 v8, v8
  v_exp_f32 v9, v9
  v_exp_f32 v10, v10
  v_exp_f32 v11, v11
  v_exp_f32 v12, v12
  v_exp_f32 v13, v13
  v_exp_f32 v14, v14
  v_exp_f32 v15, v15
  v_exp_f32 v16, v16
  v_exp_f32 v17, v17
  v_exp_f32 v18, v18
  v_exp_f32 v19, v19
  v_add_f32 v7, v8, v9
  v_add_f32 v7, v7, v10
  v_add_f32 v7, v7, v11
  v_add_f32 v7, v7, v12
  v_add_f32 v7, v7, v13
  v_add_f32 v7, v7, v14
  v_add_f32 v7, v7, v15
  v_add_f32 v7, v7, v16
  v_add_f32 v7, v7, v17
  v_add_f32 v7, v7, v18
  v_add_f32 v7, v7, v19
  v_cvt_pk_bf16_f32 v8, v8, v9
  v_cvt_pk_bf16_f32 v9, v10, v11
  v_cvt_pk_bf16_f32 v12, v12, v13
  v_cvt_pk_bf16_f32 v13, v14, v15
  v_cvt_pk_bf16_f32 v16, v16, v17
  v_cvt_pk_bf16_f32 v17, v18, v19
  v_mov_b32_dpp v10, v8 row_ror:8 row_mask:0xf bank_mask:0xf
  v_mov_b32_dpp v11, v9 row_ror:8 row_mask:0xf bank_mask:0xf
  v_mov_b32_dpp v14, v12 row_ror:8 row_mask:0xf bank_mask:0xf
  v_mov_b32_dpp v15, v13 row_ror:8 row_mask:0xf bank_mask:0xf
  v_mov_b32_dpp v18, v16 row_ror:8 row_mask:0xf bank_mask:0xf
  v_mov_b32_dpp v19, v17 row_ror:8 row_mask:0xf bank_mask:0xf
  v_add_f32_dpp v7, v7, v7 row_ror:8 row_mask:0xf bank_mask:0xf
  v_mov_b32 v5, v7
  s_nop 1
  v_permlane16_swap_b32 v7, v5
  v_add_f32 v7, v7, v5
  v_mov_b32 v5, v7
  s_nop 1
  v_permlane32_swap_b32 v7, v5
  v_add_f32 v7, v7, v5
  s_waitcnt lgkmcnt(0)
  v_perm_b32 v60, v124, v112, s62
  v_perm_b32 v61, v140, v132, s62
  v_perm_b32 v62, v128, v116, s62
  v_perm_b32 v63, v144, v136, s62
  v_perm_b32 v64, v124, v112, s63
  v_perm_b32 v65, v140, v132, s63
  v_perm_b32 v66, v128, v116, s63
  v_perm_b32 v67, v144, v136, s63
  v_perm_b32 v68, v125, v113, s62
  v_perm_b32 v69, v141, v133, s62
  v_perm_b32 v70, v129, v117, s62
  v_perm_b32 v71, v145, v137, s62
  v_perm_b32 v72, v125, v113, s63
  v_perm_b32 v73, v141, v133, s63
  v_perm_b32 v74, v129, v117, s63
  v_perm_b32 v75, v145, v137, s63
  v_mfma_f32_16x16x32_bf16 v[28:31], v[60:63], v[8:11], 0
  v_mfma_f32_16x16x32_bf16 v[32:35], v[64:67], v[8:11], 0
  v_mfma_f32_16x16x32_bf16 v[36:39], v[68:71], v[8:11], 0
  v_mfma_f32_16x16x32_bf16 v[40:43], v[72:75], v[8:11], 0
  v_perm_b32 v60, v126, v114, s62
  v_perm_b32 v61, v142, v134, s62
  v_perm_b32 v62, v130, v118, s62
  v_perm_b32 v63, v146, v138, s62
  v_perm_b32 v64, v126, v114, s63
  v_perm_b32 v65, v142, v134, s63
  v_perm_b32 v66, v130, v118, s63
  v_perm_b32 v67, v146, v138, s63
  v_perm_b32 v68, v127, v115, s62
  v_perm_b32 v69, v143, v135, s62
  v_perm_b32 v70, v131, v119, s62
  v_perm_b32 v71, v147, v139, s62
  v_perm_b32 v72, v127, v115, s63
  v_perm_b32 v73, v143, v135, s63
  v_perm_b32 v74, v131, v119, s63
  v_perm_b32 v75, v147, v139, s63
  v_mfma_f32_16x16x32_bf16 v[44:47], v[60:63], v[8:11], 0
  v_mfma_f32_16x16x32_bf16 v[48:51], v[64:67], v[8:11], 0
  v_mfma_f32_16x16x32_bf16 v[52:55], v[68:71], v[8:11], 0
  v_mfma_f32_16x16x32_bf16 v[56:59], v[72:75], v[8:11], 0
  s_waitcnt vmcnt(14)
  ds_read_b128 v[148:151], v4 offset:9216
  s_waitcnt vmcnt(13)
  ds_read_b128 v[152:155], v4 offset:10240
  s_waitcnt vmcnt(12)
  ds_read_b128 v[156:159], v4 offset:11264
  s_waitcnt vmcnt(11)
  ds_read_b128 v[160:163], v4 offset:12288
  s_waitcnt vmcnt(10)
  ds_read_b128 v[164:167], v4 offset:13312
  s_waitcnt vmcnt(9)
  ds_read_b128 v[108:111], v4 offset:14336
  s_add_u32 s64, s100, 0x0
  s_waitcnt vmcnt(7)
  buffer_load_dwordx4 v[112:115], v2, s[12:15], s64 offen offset:3072 nt
  s_waitcnt vmcnt(8)
  s_waitcnt lgkmcnt(0)
  v_perm_b32 v60, v156, v148, s62
  v_perm_b32 v61, v76, v164, s62
  v_perm_b32 v62, v160, v152, s62
  v_perm_b32 v63, v80, v108, s62
  v_perm_b32 v64, v156, v148, s63
  v_perm_b32 v65, v76, v164, s63
  v_perm_b32 v66, v160, v152, s63
  v_perm_b32 v67, v80, v108, s63
  v_perm_b32 v68, v157, v149, s62
  v_perm_b32 v69, v77, v165, s62
  v_perm_b32 v70, v161, v153, s62
  v_perm_b32 v71, v81, v109, s62
  v_perm_b32 v72, v157, v149, s63
  v_perm_b32 v73, v77, v165, s63
  v_perm_b32 v74, v161, v153, s63
  v_perm_b32 v75, v81, v109, s63
  v_mfma_f32_16x16x32_bf16 v[28:31], v[60:63], v[12:15], v[28:31]
  v_mfma_f32_16x16x32_bf16 v[32:35], v[64:67], v[12:15], v[32:35]
  v_mfma_f32_16x16x32_bf16 v[36:39], v[68:71], v[12:15], v[36:39]
  v_mfma_f32_16x16x32_bf16 v[40:43], v[72:75], v[12:15], v[40:43]
  v_perm_b32 v60, v158, v150, s62
  v_perm_b32 v61, v78, v166, s62
  v_perm_b32 v62, v162, v154, s62
  v_perm_b32 v63, v82, v110, s62
  v_perm_b32 v64, v158, v150, s63
  v_perm_b32 v65, v78, v166, s63
  v_perm_b32 v66, v162, v154, s63
  v_perm_b32 v67, v82, v110, s63
  v_perm_b32 v68, v159, v151, s62
  v_perm_b32 v69, v79, v167, s62
  v_perm_b32 v70, v163, v155, s62
  v_perm_b32 v71, v83, v111, s62
  v_perm_b32 v72, v159, v151, s63
  v_perm_b32 v73, v79, v167, s63
  v_perm_b32 v74, v163, v155, s63
  v_perm_b32 v75, v83, v111, s63
  v_mfma_f32_16x16x32_bf16 v[44:47], v[60:63], v[12:15], v[44:47]
  v_mfma_f32_16x16x32_bf16 v[48:51], v[64:67], v[12:15], v[48:51]
  v_mfma_f32_16x16x32_bf16 v[52:55], v[68:71], v[12:15], v[52:55]
  v_mfma_f32_16x16x32_bf16 v[56:59], v[72:75], v[12:15], v[56:59]
  v_mov_b32 v27, -1
  s_cmp_ge_u32 s3, 2
  s_cbranch_scc1 L_tk_26
  s_lshl_b32 s101, s25, 3
  s_and_b32 s64, s3, 1
  s_add_u32 s101, s101, s64
  s_lshl_b32 s101, s101, 8
  s_add_u32 s101, s101, 0x2b0000
  v_mov_b32 v27, 1
  s_and_b64 exec, s[26:27], 0x1
  buffer_atomic_add v27, v3, s[16:19], s101 offen sc0 sc1
  s_mov_b64 exec, s[26:27]
L_tk_26:
  s_waitcnt vmcnt(0)
  v_perm_b32 v60, v92, v84, s62
  v_perm_b32 v61, v120, v100, s62
  v_perm_b32 v62, v96, v88, s62
  v_perm_b32 v63, v112, v104, s62
  v_perm_b32 v64, v92, v84, s63
  v_perm_b32 v65, v120, v100, s63
  v_perm_b32 v66, v96, v88, s63
  v_perm_b32 v67, v112, v104, s63
  v_perm_b32 v68, v93, v85, s62
  v_perm_b32 v69, v121, v101, s62
  v_perm_b32 v70, v97, v89, s62
  v_perm_b32 v71, v113, v105, s62
  v_perm_b32 v72, v93, v85, s63
  v_perm_b32 v73, v121, v101, s63
  v_perm_b32 v74, v97, v89, s63
  v_perm_b32 v75, v113, v105, s63
  v_mfma_f32_16x16x32_bf16 v[28:31], v[60:63], v[16:19], v[28:31]
  v_mfma_f32_16x16x32_bf16 v[32:35], v[64:67], v[16:19], v[32:35]
  v_mfma_f32_16x16x32_bf16 v[36:39], v[68:71], v[16:19], v[36:39]
  v_mfma_f32_16x16x32_bf16 v[40:43], v[72:75], v[16:19], v[40:43]
  v_perm_b32 v60, v94, v86, s62
  v_perm_b32 v61, v122, v102, s62
  v_perm_b32 v62, v98, v90, s62
  v_perm_b32 v63, v114, v106, s62
  v_perm_b32 v64, v94, v86, s63
  v_perm_b32 v65, v122, v102, s63
  v_perm_b32 v66, v98, v90, s63
  v_perm_b32 v67, v114, v106, s63
  v_perm_b32 v68, v95, v87, s62
  v_perm_b32 v69, v123, v103, s62
  v_perm_b32 v70, v99, v91, s62
  v_perm_b32 v71, v115, v107, s62
  v_perm_b32 v72, v95, v87, s63
  v_perm_b32 v73, v123, v103, s63
  v_perm_b32 v74, v99, v91, s63
  v_perm_b32 v75, v115, v107, s63
  v_mfma_f32_16x16x32_bf16 v[44:47], v[60:63], v[16:19], v[44:47]
  v_mfma_f32_16x16x32_bf16 v[48:51], v[64:67], v[16:19], v[48:51]
  v_mfma_f32_16x16x32_bf16 v[52:55], v[68:71], v[16:19], v[52:55]
  v_mfma_f32_16x16x32_bf16 v[56:59], v[72:75], v[16:19], v[56:59]
  s_branch L_st_dyn
L_st_s3:
L_st_dyn:
  s_and_b32 s64, s3, 1
  s_mul_i32 s64, s64, 212
  s_add_u32 s64, s64, 3248
  s_lshl_b32 s7, s64, 12
  s_lshl_b32 s64, s25, 24
  s_add_u32 s7, s7, s64
  v_and_b32 v5, 7, v0
  v_lshlrev_b32 v5, 8, v5
  v_lshrrev_b32 v4, 4, v0
  v_lshl_add_u32 v5, v4, 6, v5
  v_bfe_u32 v4, v0, 3, 1
  v_lshl_add_u32 v5, v4, 4, v5
L_dyn:
  s_waitcnt vmcnt(0)
  v_readfirstlane_b32 s65, v27
  s_nop 0
  s_cmp_ge_u32 s65, 212
  s_cbranch_scc1 L_st_fin
  s_lshl_b32 s65, s65, 12
  s_add_u32 s64, s65, s7
  s_add_u32 s65, s64, 1736704
  buffer_load_dwordx4 v[76:79], v1, s[8:11], s64 offen offset:0 nt
  buffer_load_dwordx4 v[80:83], v1, s[8:11], s64 offen offset:1024 nt
  buffer_load_dwordx4 v[84:87], v1, s[8:11], s64 offen offset:2048 nt
  buffer_load_dwordx4 v[88:91], v1, s[8:11], s64 offen offset:3072 nt
  buffer_load_dwordx4 v[92:95], v1, s[8:11], s65 offen offset:0 nt
  buffer_load_dwordx4 v[96:99], v1, s[8:11], s65 offen offset:1024 nt
  buffer_load_dwordx4 v[100:103], v1, s[8:11], s65 offen offset:2048 nt
  buffer_load_dwordx4 v[104:107], v1, s[8:11], s65 offen offset:3072 nt
  buffer_load_dwordx4 v[108:111], v2, s[12:15], s64 offen offset:0 nt
  buffer_load_dwordx4 v[112:115], v2, s[12:15], s64 offen offset:1024 nt
  buffer_load_dwordx4 v[116:119], v2, s[12:15], s64 offen offset:2048 nt
  buffer_load_dwordx4 v[120:123], v2, s[12:15], s64 offen offset:3072 nt
  buffer_load_dwordx4 v[124:127], v2, s[12:15], s65 offen offset:0 nt
  buffer_load_dwordx4 v[128:131], v2, s[12:15], s65 offen offset:1024 nt
  buffer_load_dwordx4 v[132:135], v2, s[12:15], s65 offen offset:2048 nt
  buffer_load_dwordx4 v[136:139], v2, s[12:15], s65 offen offset:3072 nt
  v_mov_b32 v27, 1
  s_and_b64 exec, s[26:27], 0x1
  buffer_atomic_add v27, v3, s[16:19], s101 offen sc0 sc1
  s_mov_b64 exec, s[26:27]
L_dyn_have:
  ds_read_b128 v[60:63], v5 offset:256
  ds_read_b128 v[64:67], v5 offset:288
  s_waitcnt lgkmcnt(0)
  s_waitcnt vmcnt(15)
  v_mfma_f32_16x16x32_bf16 v[140:143], v[76:79], v[60:63], 0
  v_mfma_f32_16x16x32_bf16 v[144:147], v[76:79], v[64:67], 0
  v_mfma_f32_16x16x32_bf16 v[148:151], v[80:83], v[60:63], 0
  v_mfma_f32_16x16x32_bf16 v[152:155], v[80:83], v[64:67], 0
  s_nop 5
  v_add_f32 v156, v140, v146
  v_add_f32 v157, v141, v147
  v_add_f32 v158, v148, v154
  v_add_f32 v159, v149, v155
  v_add_f32_dpp v8, v157, v156 row_ror:8 row_mask:0xf bank_mask:0x3
  s_nop 1
  v_add_f32_dpp v8, v158, v159 row_ror:8 row_mask:0xf bank_mask:0xc
  s_waitcnt vmcnt(13)
  v_mfma_f32_16x16x32_bf16 v[140:143], v[84:87], v[60:63], 0
  v_mfma_f32_16x16x32_bf16 v[144:147], v[84:87], v[64:67], 0
  v_mfma_f32_16x16x32_bf16 v[148:151], v[88:91], v[60:63], 0
  v_mfma_f32_16x16x32_bf16 v[152:155], v[88:91], v[64:67], 0
  s_nop 5
  v_add_f32 v156, v140, v146
  v_add_f32 v157, v141, v147
  v_add_f32 v158, v148, v154
  v_add_f32 v159, v149, v155
  v_add_f32_dpp v9, v157, v156 row_ror:8 row_mask:0xf bank_mask:0x3
  s_nop 1
  v_add_f32_dpp v9, v158, v159 row_ror:8 row_mask:0xf bank_mask:0xc
  s_waitcnt vmcnt(11)
  v_mfma_f32_16x16x32_bf16 v[140:143], v[92:95], v[60:63], 0
  v_mfma_f32_16x16x32_bf16 v[144:147], v[92:95], v[64:67], 0
  v_mfma_f32_16x16x32_bf16 v[148:151], v[96:99], v[60:63], 0
  v_mfma_f32_16x16x32_bf16 v[152:155], v[96:99], v[64:67], 0
  s_nop 5
  v_add_f32 v156, v140, v146
  v_add_f32 v157, v141, v147
  v_add_f32 v158, v148, v154
  v_add_f32 v159, v149, v155
  v_add_f32_dpp v10, v157, v156 row_ror:8 row_mask:0xf bank_mask:0x3
  s_nop 1
  v_add_f32_dpp v10, v158, v159 row_ror:8 row_mask:0xf bank_mask:0xc
  s_waitcnt vmcnt(9)
  v_mfma_f32_16x16x32_bf16 v[140:143], v[100:103], v[60:63], 0
  v_mfma_f32_16x16x32_bf16 v[144:147], v[100:103], v[64:67], 0
  v_mfma_f32_16x16x32_bf16 v[148:151], v[104:107], v[60:63], 0
  v_mfma_f32_16x16x32_bf16 v[152:155], v[104:107], v[64:67], 0
  s_nop 5
  v_add_f32 v156, v140, v146
  v_add_f32 v157, v141, v147
  v_add_f32 v158, v148, v154
  v_add_f32 v159, v149, v155
  v_add_f32_dpp v11, v157, v156 row_ror:8 row_mask:0xf bank_mask:0x3
  s_nop 1
  v_add_f32_dpp v11, v158, v159 row_ror:8 row_mask:0xf bank_mask:0xc
  v_cvt_pk_bf16_f32 v164, v8, v9
  v_lshlrev_b32 v8, 16, v164
  v_and_b32 v9, 0xffff0000, v164
  v_mul_f32 v8, s78, v8
  v_mul_f32 v9, s78, v9
  v_cvt_pk_bf16_f32 v164, v8, v9
  v_lshlrev_b32 v8, 16, v164
  v_and_b32 v9, 0xffff0000, v164
  v_cvt_pk_bf16_f32 v164, v10, v11
  v_lshlrev_b32 v10, 16, v164
  v_and_b32 v11, 0xffff0000, v164
  v_mul_f32 v10, s78, v10
  v_mul_f32 v11, s78, v11
  v_cvt_pk_bf16_f32 v164, v10, v11
  v_lshlrev_b32 v10, 16, v164
  v_and_b32 v11, 0xffff0000, v164
  v_max3_f32 v164, v8, v9, v10
  v_max3_f32 v164, v164, v11, v6
  s_nop 1
  v_max_f32_dpp v164, v164, v164 row_ror:8 row_mask:0xf bank_mask:0xf
  v_mov_b32 v165, v164
  s_nop 1
  v_permlane16_swap_b32 v164, v165
  v_max_f32 v164, v164, v165
  v_mov_b32 v165, v164
  s_nop 1
  v_permlane32_swap_b32 v164, v165
  v_max_f32 v164, v164, v165
  v_sub_f32 v166, v6, v164
  v_mul_f32 v166, s79, v166
  v_exp_f32 v166, v166
  v_mov_b32 v6, v164
  v_mul_f32 v165, s79, v164
  v_fma_f32 v8, v8, s79, -v165
  v_fma_f32 v9, v9, s79, -v165
  v_fma_f32 v10, v10, s79, -v165
  v_fma_f32 v11, v11, s79, -v165
  v_exp_f32 v8, v8
  v_exp_f32 v9, v9
  v_exp_f32 v10, v10
  v_exp_f32 v11, v11
  v_add_f32 v164, v8, v9
  v_add_f32 v165, v10, v11
  v_add_f32 v164, v164, v165
  v_cvt_pk_bf16_f32 v8, v8, v9
  v_cvt_pk_bf16_f32 v9, v10, v11
  v_add_f32_dpp v164, v164, v164 row_ror:8 row_mask:0xf bank_mask:0xf
  v_mov_b32 v165, v164
  s_nop 1
  v_permlane16_swap_b32 v164, v165
  v_add_f32 v164, v164, v165
  v_mov_b32 v165, v164
  s_nop 1
  v_permlane32_swap_b32 v164, v165
  v_add_f32 v164, v164, v165
  v_mov_b32_dpp v10, v8 row_ror:8 row_mask:0xf bank_mask:0xf
  v_mov_b32_dpp v11, v9 row_ror:8 row_mask:0xf bank_mask:0xf
  v_fma_f32 v7, v7, v166, v164
  v_mul_f32 v28, v28, v166
  v_mul_f32 v29, v29, v166
  v_mul_f32 v30, v30, v166
  v_mul_f32 v31, v31, v166
  v_mul_f32 v32, v32, v166
  v_mul_f32 v33, v33, v166
  v_mul_f32 v34, v34, v166
  v_mul_f32 v35, v35, v166
  v_mul_f32 v36, v36, v166
  v_mul_f32 v37, v37, v166
  v_mul_f32 v38, v38, v166
  v_mul_f32 v39, v39, v166
  v_mul_f32 v40, v40, v166
  v_mul_f32 v41, v41, v166
  v_mul_f32 v42, v42, v166
  v_mul_f32 v43, v43, v166
  v_mul_f32 v44, v44, v166
  v_mul_f32 v45, v45, v166
  v_mul_f32 v46, v46, v166
  v_mul_f32 v47, v47, v166
  v_mul_f32 v48, v48, v166
  v_mul_f32 v49, v49, v166
  v_mul_f32 v50, v50, v166
  v_mul_f32 v51, v51, v166
  v_mul_f32 v52, v52, v166
  v_mul_f32 v53, v53, v166
  v_mul_f32 v54, v54, v166
  v_mul_f32 v55, v55, v166
  v_mul_f32 v56, v56, v166
  v_mul_f32 v57, v57, v166
  v_mul_f32 v58, v58, v166
  v_mul_f32 v59, v59, v166
  s_waitcnt vmcnt(1)
  v_perm_b32 v60, v116, v108, s62
  v_perm_b32 v61, v132, v124, s62
  v_perm_b32 v62, v120, v112, s62
  v_perm_b32 v63, v136, v128, s62
  v_perm_b32 v64, v116, v108, s63
  v_perm_b32 v65, v132, v124, s63
  v_perm_b32 v66, v120, v112, s63
  v_perm_b32 v67, v136, v128, s63
  v_perm_b32 v68, v117, v109, s62
  v_perm_b32 v69, v133, v125, s62
  v_perm_b32 v70, v121, v113, s62
  v_perm_b32 v71, v137, v129, s62
  v_perm_b32 v72, v117, v109, s63
  v_perm_b32 v73, v133, v125, s63
  v_perm_b32 v74, v121, v113, s63
  v_perm_b32 v75, v137, v129, s63
  v_mfma_f32_16x16x32_bf16 v[28:31], v[60:63], v[8:11], v[28:31]
  v_mfma_f32_16x16x32_bf16 v[32:35], v[64:67], v[8:11], v[32:35]
  v_mfma_f32_16x16x32_bf16 v[36:39], v[68:71], v[8:11], v[36:39]
  v_mfma_f32_16x16x32_bf16 v[40:43], v[72:75], v[8:11], v[40:43]
  v_perm_b32 v60, v118, v110, s62
  v_perm_b32 v61, v134, v126, s62
  v_perm_b32 v62, v122, v114, s62
  v_perm_b32 v63, v138, v130, s62
  v_perm_b32 v64, v118, v110, s63
  v_perm_b32 v65, v134, v126, s63
  v_perm_b32 v66, v122, v114, s63
  v_perm_b32 v67, v138, v130, s63
  v_perm_b32 v68, v119, v111, s62
  v_perm_b32 v69, v135, v127, s62
  v_perm_b32 v70, v123, v115, s62
  v_perm_b32 v71, v139, v131, s62
  v_perm_b32 v72, v119, v111, s63
  v_perm_b32 v73, v135, v127, s63
  v_perm_b32 v74, v123, v115, s63
  v_perm_b32 v75, v139, v131, s63
  v_mfma_f32_16x16x32_bf16 v[44:47], v[60:63], v[8:11], v[44:47]
  v_mfma_f32_16x16x32_bf16 v[48:51], v[64:67], v[8:11], v[48:51]
  v_mfma_f32_16x16x32_bf16 v[52:55], v[68:71], v[8:11], v[52:55]
  v_mfma_f32_16x16x32_bf16 v[56:59], v[72:75], v[8:11], v[56:59]
  s_branch L_dyn
L_st_fin:
  v_and_b32 v4, 7, v0
  v_lshlrev_b32 v5, 9, v4
  v_lshlrev_b32 v4, 6, v4
  v_lshrrev_b32 v140, 4, v0
  v_lshl_add_u32 v5, v140, 4, v5
  s_lshl_b32 s64, s3, 12
  v_add_u32 v5, s64, v5
  s_movk_i32 s66, 0x1c0
  v_add_u32 v140, 0, v4
  v_and_or_b32 v140, v140, s66, v5
  v_add_u32 v141, 64, v4
  v_and_or_b32 v141, v141, s66, v5
  v_add_u32 v142, 128, v4
  v_and_or_b32 v142, v142, s66, v5
  v_add_u32 v143, 192, v4
  v_and_or_b32 v143, v143, s66, v5
  v_add_u32 v144, 256, v4
  v_and_or_b32 v144, v144, s66, v5
  v_add_u32 v145, 320, v4
  v_and_or_b32 v145, v145, s66, v5
  v_add_u32 v146, 384, v4
  v_and_or_b32 v146, v146, s66, v5
  v_add_u32 v147, 448, v4
  v_and_or_b32 v147, v147, s66, v5
  s_lshl_b32 s65, s3, 3
  v_add_u32 v4, s65, v4
  s_mov_b32 s64, 0x00ff00ff
  s_mov_b32 s65, 0x00ff00ff
  s_and_b64 exec, s[26:27], s[64:65]
  ds_write_b128 v140, v[28:31] offset:8192
  ds_write_b128 v141, v[32:35] offset:8192
  ds_write_b128 v142, v[36:39] offset:8192
  ds_write_b128 v143, v[40:43] offset:8192
  ds_write_b128 v144, v[44:47] offset:8192
  ds_write_b128 v145, v[48:51] offset:8192
  ds_write_b128 v146, v[52:55] offset:8192
  ds_write_b128 v147, v[56:59] offset:8192
  s_and_b64 exec, s[26:27], 0xff
  ds_write_b64 v4, v[6:7] offset:5376
  s_mov_b64 exec, s[26:27]
  s_lshl_b32 s64, s3, 6
  v_mov_b32 v5, s64
  v_mov_b32 v117, s4
  v_mov_b32 v119, s4
  v_mov_b32 v121, s4
  v_mov_b32 v123, s4
  s_mov_b32 s64, 1
  s_mov_b32 s65, 1
  s_mov_b32 s68, 0
L_ls_27:
  s_sleep 2
  ds_read_b128 v[76:79], v5 offset:5376
  ds_read_b128 v[80:83], v5 offset:5392
  ds_read_b128 v[84:87], v5 offset:5408
  ds_read_b128 v[88:91], v5 offset:5424
  s_add_u32 s68, s68, 1
  s_cmp_gt_u32 s68, 0x400000
  s_cbranch_scc1 L_fail
  s_waitcnt lgkmcnt(0)
  v_max3_u32 v4, v77, v79, v81
  v_max3_u32 v4, v4, v83, v85
  v_max3_u32 v4, v4, v87, v89
  v_max_u32 v4, v4, v91
  v_cmp_eq_u32 vcc, -1, v4
  s_nop 0
  s_cmp_eq_u64 vcc, 0
  s_cbranch_scc0 L_ls_27
  ds_read_b64 v[92:93], v24 offset:8192
  ds_read_b64 v[94:95], v24 offset:12288
  ds_read_b64 v[96:97], v24 offset:16384
  ds_read_b64 v[98:99], v24 offset:20480
  ds_read_b64 v[100:101], v24 offset:24576
  ds_read_b64 v[102:103], v24 offset:28672
  ds_read_b64 v[104:105], v24 offset:32768
  ds_read_b64 v[106:107], v24 offset:36864
  v_max3_f32 v120, v76, v78, v80
  v_max3_f32 v120, v120, v82, v84
  v_max3_f32 v120, v120, v86, v88
  v_max_f32 v120, v120, v90
  v_sub_f32 v108, v76, v120
  v_sub_f32 v109, v78, v120
  v_sub_f32 v110, v80, v120
  v_sub_f32 v111, v82, v120
  v_sub_f32 v112, v84, v120
  v_sub_f32 v113, v86, v120
  v_sub_f32 v114, v88, v120
  v_sub_f32 v115, v90, v120
  v_mul_f32 v108, s79, v108
  v_mul_f32 v109, s79, v109
  v_mul_f32 v110, s79, v110
  v_mul_f32 v111, s79, v111
  v_mul_f32 v112, s79, v112
  v_mul_f32 v113, s79, v113
  v_mul_f32 v114, s79, v114
  v_mul_f32 v115, s79, v115
  v_exp_f32 v108, v108
  v_exp_f32 v109, v109
  v_exp_f32 v110, v110
  v_exp_f32 v111, v111
  v_exp_f32 v112, v112
  v_exp_f32 v113, v113
  v_exp_f32 v114, v114
  v_exp_f32 v115, v115
  v_mul_f32 v122, v108, v77
  v_fmac_f32 v122, v109, v79
  v_fmac_f32 v122, v110, v81
  v_fmac_f32 v122, v111, v83
  v_fmac_f32 v122, v112, v85
  v_fmac_f32 v122, v113, v87
  v_fmac_f32 v122, v114, v89
  v_fmac_f32 v122, v115, v91
  s_waitcnt lgkmcnt(0)
  v_mul_f32 v116, v108, v92
  v_mul_f32 v118, v108, v93
  v_fmac_f32 v116, v109, v94
  v_fmac_f32 v118, v109, v95
  v_fmac_f32 v116, v110, v96
  v_fmac_f32 v118, v110, v97
  v_fmac_f32 v116, v111, v98
  v_fmac_f32 v118, v111, v99
  v_fmac_f32 v116, v112, v100
  v_fmac_f32 v118, v112, v101
  v_fmac_f32 v116, v113, v102
  v_fmac_f32 v118, v113, v103
  v_fmac_f32 v116, v114, v104
  v_fmac_f32 v118, v114, v105
  v_fmac_f32 v116, v115, v106
  v_fmac_f32 v118, v115, v107
  s_cbranch_execz L_st_28
  buffer_store_dwordx4 v[116:119], v25, s[16:19], s82 offen offset:0 sc1
L_st_28:
  s_and_b64 exec, s[26:27], s[64:65]
  s_cbranch_execz L_st_29
  buffer_store_dwordx4 v[120:123], v26, s[16:19], s83 offen offset:0 sc1
L_st_29:
  s_mov_b64 exec, s[26:27]
  v_mov_b32 v4, 1
  s_waitcnt lgkmcnt(0)
  s_and_b64 exec, s[26:27], 0x1
  ds_add_u32 v3, v4 offset:40
  s_mov_b64 exec, s[26:27]
  s_cmp_ge_u32 s24, 48
  s_cbranch_scc1 L_s1c
  s_cbranch_execz L_w2
  s_sub_u32 s64, s24, 8
  s_cmp_ge_u32 s64, 14
  s_cbranch_scc1 L_end
  s_cmp_ge_u32 s3, 4
  s_cbranch_scc1 L_end
L_w2:
  s_mul_i32 s6, s25, 14
  s_add_u32 s6, s6, s24
  s_sub_u32 s6, s6, 8
  s_mov_b32 s20, s48
  s_and_b32 s21, s49, 0xffff
  s_mov_b32 s22, 0x700000
  s_mov_b32 s23, 0x20000
  v_lshrrev_b32 v1, 5, v0
  v_lshlrev_b32 v1, 14, v1
  v_and_b32 v4, 31, v0
  v_lshl_add_u32 v1, v4, 4, v1
  s_lshl_b32 s7, s6, 17
  s_lshl_b32 s64, s5, 9
  s_add_u32 s7, s7, s64
  s_mov_b32 s68, 0
L_w_30:
  s_sleep 1
  s_add_u32 s68, s68, 1
  s_cmp_gt_u32 s68, 0x400000
  s_cbranch_scc1 L_fail
  ds_read_b32 v4, v3 offset:40
  s_waitcnt lgkmcnt(0)
  v_readfirstlane_b32 s67, v4
  s_nop 0
  s_cmp_ge_u32 s67, 8
  s_cbranch_execz L_wd_31
  s_cbranch_scc0 L_w_30
L_wd_31:
  s_add_u32 s64, s7, 0x0
  buffer_load_dwordx4 v[8:11], v1, s[20:23], s64 offen nt
  s_add_u32 s64, s7, 0x800
  buffer_load_dwordx4 v[12:15], v1, s[20:23], s64 offen nt
  s_add_u32 s64, s7, 0x1000
  buffer_load_dwordx4 v[16:19], v1, s[20:23], s64 offen nt
  s_add_u32 s64, s7, 0x1800
  buffer_load_dwordx4 v[20:23], v1, s[20:23], s64 offen nt
  s_add_u32 s64, s7, 0x2000
  buffer_load_dwordx4 v[24:27], v1, s[20:23], s64 offen nt
  s_add_u32 s64, s7, 0x2800
  buffer_load_dwordx4 v[28:31], v1, s[20:23], s64 offen nt
  s_add_u32 s64, s7, 0x3000
  buffer_load_dwordx4 v[32:35], v1, s[20:23], s64 offen nt
  s_add_u32 s64, s7, 0x3800
  buffer_load_dwordx4 v[36:39], v1, s[20:23], s64 offen nt
  s_add_u32 s64, s7, 0x8000
  buffer_load_dwordx4 v[40:43], v1, s[20:23], s64 offen nt
  s_add_u32 s64, s7, 0x8800
  buffer_load_dwordx4 v[44:47], v1, s[20:23], s64 offen nt
  s_add_u32 s64, s7, 0x9000
  buffer_load_dwordx4 v[48:51], v1, s[20:23], s64 offen nt
  s_add_u32 s64, s7, 0x9800
  buffer_load_dwordx4 v[52:55], v1, s[20:23], s64 offen nt
  s_add_u32 s64, s7, 0xa000
  buffer_load_dwordx4 v[56:59], v1, s[20:23], s64 offen nt
  s_add_u32 s64, s7, 0xa800
  buffer_load_dwordx4 v[60:63], v1, s[20:23], s64 offen nt
  s_add_u32 s64, s7, 0xb000
  buffer_load_dwordx4 v[64:67], v1, s[20:23], s64 offen nt
  s_add_u32 s64, s7, 0xb800
  buffer_load_dwordx4 v[68:71], v1, s[20:23], s64 offen nt
  s_add_u32 s64, s7, 0x10000
  buffer_load_dwordx4 v[72:75], v1, s[20:23], s64 offen nt
  s_add_u32 s64, s7, 0x10800
  buffer_load_dwordx4 v[76:79], v1, s[20:23], s64 offen nt
  s_add_u32 s64, s7, 0x11000
  buffer_load_dwordx4 v[80:83], v1, s[20:23], s64 offen nt
  s_add_u32 s64, s7, 0x11800
  buffer_load_dwordx4 v[84:87], v1, s[20:23], s64 offen nt
  s_add_u32 s64, s7, 0x12000
  buffer_load_dwordx4 v[88:91], v1, s[20:23], s64 offen nt
  s_add_u32 s64, s7, 0x12800
  buffer_load_dwordx4 v[92:95], v1, s[20:23], s64 offen nt
  s_add_u32 s64, s7, 0x13000
  buffer_load_dwordx4 v[96:99], v1, s[20:23], s64 offen nt
  s_add_u32 s64, s7, 0x13800
  buffer_load_dwordx4 v[100:103], v1, s[20:23], s64 offen nt
  s_add_u32 s64, s7, 0x18000
  buffer_load_dwordx4 v[104:107], v1, s[20:23], s64 offen nt
  s_add_u32 s64, s7, 0x18800
  buffer_load_dwordx4 v[108:111], v1, s[20:23], s64 offen nt
  s_add_u32 s64, s7, 0x19000
  buffer_load_dwordx4 v[112:115], v1, s[20:23], s64 offen nt
  s_add_u32 s64, s7, 0x19800
  buffer_load_dwordx4 v[116:119], v1, s[20:23], s64 offen nt
  s_add_u32 s64, s7, 0x1a000
  buffer_load_dwordx4 v[120:123], v1, s[20:23], s64 offen nt
  s_add_u32 s64, s7, 0x1a800
  buffer_load_dwordx4 v[124:127], v1, s[20:23], s64 offen nt
  s_add_u32 s64, s7, 0x1b000
  buffer_load_dwordx4 v[128:131], v1, s[20:23], s64 offen nt
  s_add_u32 s64, s7, 0x1b800
  buffer_load_dwordx4 v[132:135], v1, s[20:23], s64 offen nt
  s_cbranch_execz L_vw_32
  s_waitcnt vmcnt(24)
L_vw_32:
  v_perm_b32 v136, v12, v8, s62
  v_perm_b32 v137, v20, v16, s62
  v_perm_b32 v138, v28, v24, s62
  v_perm_b32 v139, v36, v32, s62
  v_perm_b32 v140, v12, v8, s63
  v_perm_b32 v141, v20, v16, s63
  v_perm_b32 v142, v28, v24, s63
  v_perm_b32 v143, v36, v32, s63
  v_perm_b32 v144, v13, v9, s62
  v_perm_b32 v145, v21, v17, s62
  v_perm_b32 v146, v29, v25, s62
  v_perm_b32 v147, v37, v33, s62
  v_perm_b32 v148, v13, v9, s63
  v_perm_b32 v149, v21, v17, s63
  v_perm_b32 v150, v29, v25, s63
  v_perm_b32 v151, v37, v33, s63
  v_perm_b32 v152, v14, v10, s62
  v_perm_b32 v153, v22, v18, s62
  v_perm_b32 v154, v30, v26, s62
  v_perm_b32 v155, v38, v34, s62
  v_perm_b32 v156, v14, v10, s63
  v_perm_b32 v157, v22, v18, s63
  v_perm_b32 v158, v30, v26, s63
  v_perm_b32 v159, v38, v34, s63
  v_perm_b32 v160, v15, v11, s62
  v_perm_b32 v161, v23, v19, s62
  v_perm_b32 v162, v31, v27, s62
  v_perm_b32 v163, v39, v35, s62
  v_perm_b32 v164, v15, v11, s63
  v_perm_b32 v165, v23, v19, s63
  v_perm_b32 v166, v31, v27, s63
  v_perm_b32 v167, v39, v35, s63
  s_cbranch_execz L_vw_33
  s_waitcnt vmcnt(16)
L_vw_33:
  v_perm_b32 v8, v44, v40, s62
  v_perm_b32 v9, v52, v48, s62
  v_perm_b32 v10, v60, v56, s62
  v_perm_b32 v11, v68, v64, s62
  v_perm_b32 v12, v44, v40, s63
  v_perm_b32 v13, v52, v48, s63
  v_perm_b32 v14, v60, v56, s63
  v_perm_b32 v15, v68, v64, s63
  v_perm_b32 v16, v45, v41, s62
  v_perm_b32 v17, v53, v49, s62
  v_perm_b32 v18, v61, v57, s62
  v_perm_b32 v19, v69, v65, s62
  v_perm_b32 v20, v45, v41, s63
  v_perm_b32 v21, v53, v49, s63
  v_perm_b32 v22, v61, v57, s63
  v_perm_b32 v23, v69, v65, s63
  v_perm_b32 v24, v46, v42, s62
  v_perm_b32 v25, v54, v50, s62
  v_perm_b32 v26, v62, v58, s62
  v_perm_b32 v27, v70, v66, s62
  v_perm_b32 v28, v46, v42, s63
  v_perm_b32 v29, v54, v50, s63
  v_perm_b32 v30, v62, v58, s63
  v_perm_b32 v31, v70, v66, s63
  v_perm_b32 v32, v47, v43, s62
  v_perm_b32 v33, v55, v51, s62
  v_perm_b32 v34, v63, v59, s62
  v_perm_b32 v35, v71, v67, s62
  v_perm_b32 v36, v47, v43, s63
  v_perm_b32 v37, v55, v51, s63
  v_perm_b32 v38, v63, v59, s63
  v_perm_b32 v39, v71, v67, s63
  s_cbranch_execz L_vw_34
  s_waitcnt vmcnt(8)
L_vw_34:
  v_perm_b32 v40, v76, v72, s62
  v_perm_b32 v41, v84, v80, s62
  v_perm_b32 v42, v92, v88, s62
  v_perm_b32 v43, v100, v96, s62
  v_perm_b32 v44, v76, v72, s63
  v_perm_b32 v45, v84, v80, s63
  v_perm_b32 v46, v92, v88, s63
  v_perm_b32 v47, v100, v96, s63
  v_perm_b32 v48, v77, v73, s62
  v_perm_b32 v49, v85, v81, s62
  v_perm_b32 v50, v93, v89, s62
  v_perm_b32 v51, v101, v97, s62
  v_perm_b32 v52, v77, v73, s63
  v_perm_b32 v53, v85, v81, s63
  v_perm_b32 v54, v93, v89, s63
  v_perm_b32 v55, v101, v97, s63
  v_perm_b32 v56, v78, v74, s62
  v_perm_b32 v57, v86, v82, s62
  v_perm_b32 v58, v94, v90, s62
  v_perm_b32 v59, v102, v98, s62
  v_perm_b32 v60, v78, v74, s63
  v_perm_b32 v61, v86, v82, s63
  v_perm_b32 v62, v94, v90, s63
  v_perm_b32 v63, v102, v98, s63
  v_perm_b32 v64, v79, v75, s62
  v_perm_b32 v65, v87, v83, s62
  v_perm_b32 v66, v95, v91, s62
  v_perm_b32 v67, v103, v99, s62
  v_perm_b32 v68, v79, v75, s63
  v_perm_b32 v69, v87, v83, s63
  v_perm_b32 v70, v95, v91, s63
  v_perm_b32 v71, v103, v99, s63
  s_cbranch_execz L_vw_35
  s_waitcnt vmcnt(0)
L_vw_35:
  v_perm_b32 v72, v108, v104, s62
  v_perm_b32 v73, v116, v112, s62
  v_perm_b32 v74, v124, v120, s62
  v_perm_b32 v75, v132, v128, s62
  v_perm_b32 v76, v108, v104, s63
  v_perm_b32 v77, v116, v112, s63
  v_perm_b32 v78, v124, v120, s63
  v_perm_b32 v79, v132, v128, s63
  v_perm_b32 v80, v109, v105, s62
  v_perm_b32 v81, v117, v113, s62
  v_perm_b32 v82, v125, v121, s62
  v_perm_b32 v83, v133, v129, s62
  v_perm_b32 v84, v109, v105, s63
  v_perm_b32 v85, v117, v113, s63
  v_perm_b32 v86, v125, v121, s63
  v_perm_b32 v87, v133, v129, s63
  v_perm_b32 v88, v110, v106, s62
  v_perm_b32 v89, v118, v114, s62
  v_perm_b32 v90, v126, v122, s62
  v_perm_b32 v91, v134, v130, s62
  v_perm_b32 v92, v110, v106, s63
  v_perm_b32 v93, v118, v114, s63
  v_perm_b32 v94, v126, v122, s63
  v_perm_b32 v95, v134, v130, s63
  v_perm_b32 v96, v111, v107, s62
  v_perm_b32 v97, v119, v115, s62
  v_perm_b32 v98, v127, v123, s62
  v_perm_b32 v99, v135, v131, s62
  v_perm_b32 v100, v111, v107, s63
  v_perm_b32 v101, v119, v115, s63
  v_perm_b32 v102, v127, v123, s63
  v_perm_b32 v103, v135, v131, s63
  s_mov_b32 s68, 0
L_w_36:
  s_sleep 1
  s_add_u32 s68, s68, 1
  s_cmp_gt_u32 s68, 0x400000
  s_cbranch_scc1 L_fail
  ds_read_b32 v4, v3 offset:32
  s_waitcnt lgkmcnt(0)
  v_readfirstlane_b32 s67, v4
  s_nop 0
  s_cmp_ge_u32 s67, 4
  s_cbranch_execz L_wd_37
  s_cbranch_scc0 L_w_36
L_wd_37:
  s_lshl_b32 s65, s3, 7
  s_add_u32 s65, s65, 7680
  v_lshrrev_b32 v1, 5, v0
  v_lshlrev_b32 v1, 4, v1
  v_add_u32 v1, s65, v1
  v_lshrrev_b32 v4, 4, v0
  v_xor_b32 v4, v4, v0
  v_and_b32 v4, 1, v4
  v_cmp_eq_u32 vcc, 0, v4
  v_mov_b32 v4, 64
  s_nop 0
  v_cndmask_b32 v1, v4, v1, vcc
  v_lshrrev_b32 v4, 4, v0
  v_cmp_eq_u32 s[72:73], 1, v4
  v_cmp_eq_u32 s[74:75], 2, v4
  v_cmp_eq_u32 s[82:83], 3, v4
  v_and_b32 v6, 15, v0
  v_lshlrev_b32 v6, 3, v6
  ds_read_b64 v[134:135], v6 offset:7552
  v_add_u32 v6, s65, v6
  v_bfe_u32 v7, v0, 2, 2
  v_mul_u32_u24 v7, 14336, v7
  v_and_b32 v4, 3, v0
  v_mul_u32_u24 v4, 3584, v4
  v_add_u32 v7, v7, v4
  v_lshrrev_b32 v4, 4, v0
  v_lshl_add_u32 v7, v4, 4, v7
  s_mul_i32 s80, s3, 114688
  s_lshl_b32 s64, s6, 6
  s_add_u32 s80, s80, s64
  s_add_u32 s80, s80, 0x600000
  s_add_u32 s81, s80, 57344
  s_mov_b32 s78, 0x3d372713
  s_mov_b32 s79, 0xc0135761
  s_waitcnt lgkmcnt(0)
  v_lshlrev_b32 v128, 16, v134
  v_and_b32 v129, 0xffff0000, v134
  v_lshlrev_b32 v130, 16, v135
  v_and_b32 v131, 0xffff0000, v135
  v_and_b32 v5, 15, v0
  v_lshlrev_b32 v5, 4, v5
  s_mov_b32 s68, 0
L_ls_38:
  s_sleep 1
  ds_read_b128 v[104:107], v5 offset:4352
  ds_read_b128 v[108:111], v5 offset:4608
  ds_read_b128 v[112:115], v5 offset:4864
  ds_read_b128 v[116:119], v5 offset:5120
  s_add_u32 s68, s68, 1
  s_cmp_gt_u32 s68, 0x400000
  s_cbranch_scc1 L_fail
  s_waitcnt lgkmcnt(0)
  v_max3_u32 v4, v104, v108, v112
  v_max_u32 v4, v4, v116
  v_cmp_eq_u32 vcc, -1, v4
  s_nop 0
  s_cmp_eq_u64 vcc, 0
  s_cbranch_scc0 L_ls_38
  s_waitcnt lgkmcnt(2)
  v_add_f32 v120, v104, v108
  v_add_f32 v121, v105, v109
  v_add_f32 v122, v106, v110
  v_add_f32 v123, v107, v111
  s_waitcnt lgkmcnt(1)
  v_add_f32 v120, v120, v112
  v_add_f32 v121, v121, v113
  v_add_f32 v122, v122, v114
  v_add_f32 v123, v123, v115
  s_waitcnt lgkmcnt(0)
  v_add_f32 v120, v120, v116
  v_add_f32 v121, v121, v117
  v_add_f32 v122, v122, v118
  v_add_f32 v123, v123, v119
  v_cvt_pk_bf16_f32 v124, v120, v121
  v_lshlrev_b32 v120, 16, v124
  v_and_b32 v121, 0xffff0000, v124
  v_cvt_pk_bf16_f32 v125, v122, v123
  v_lshlrev_b32 v122, 16, v125
  v_and_b32 v123, 0xffff0000, v125
  v_add_f32 v120, v120, v128
  v_add_f32 v121, v121, v129
  v_add_f32 v122, v122, v130
  v_add_f32 v123, v123, v131
  v_cvt_pk_bf16_f32 v124, v120, v121
  v_lshlrev_b32 v120, 16, v124
  v_and_b32 v121, 0xffff0000, v124
  v_cvt_pk_bf16_f32 v125, v122, v123
  v_lshlrev_b32 v122, 16, v125
  v_and_b32 v123, 0xffff0000, v125
  v_mul_f32 v124, v120, v120
  v_mul_f32 v125, v121, v121
  v_mul_f32 v126, v122, v122
  v_mul_f32 v127, v123, v123
  v_mul_f32 v124, v124, v120
  v_mul_f32 v125, v125, v121
  v_mul_f32 v126, v126, v122
  v_mul_f32 v127, v127, v123
  v_fma_f32 v124, v124, s78, v120
  v_fma_f32 v125, v125, s78, v121
  v_fma_f32 v126, v126, s78, v122
  v_fma_f32 v127, v127, s78, v123
  v_mul_f32 v124, s79, v124
  v_mul_f32 v125, s79, v125
  v_mul_f32 v126, s79, v126
  v_mul_f32 v127, s79, v127
  v_exp_f32 v124, v124
  v_exp_f32 v125, v125
  v_exp_f32 v126, v126
  v_exp_f32 v127, v127
  v_add_f32 v124, 1.0, v124
  v_add_f32 v125, 1.0, v125
  v_add_f32 v126, 1.0, v126
  v_add_f32 v127, 1.0, v127
  v_rcp_f32 v124, v124
  v_rcp_f32 v125, v125
  v_rcp_f32 v126, v126
  v_rcp_f32 v127, v127
  v_mul_f32 v120, v120, v124
  v_mul_f32 v121, v121, v125
  v_mul_f32 v122, v122, v126
  v_mul_f32 v123, v123, v127
  v_cvt_pk_bf16_f32 v124, v120, v121
  v_cvt_pk_bf16_f32 v125, v122, v123
  s_and_b64 exec, s[26:27], 0xffff
  ds_write_b64 v6, v[124:125]
  s_mov_b64 exec, s[26:27]
  ds_read_b128 v[120:123], v1 offset:0
  ds_read_b128 v[124:127], v1 offset:32
  ds_read_b128 v[128:131], v1 offset:64
  ds_read_b128 v[132:135], v1 offset:96
  s_cbranch_execz L_ms_39
  s_waitcnt lgkmcnt(3)
  v_mfma_f32_16x16x32_bf16 v[104:107], v[120:123], v[136:139], 0
  v_mfma_f32_16x16x32_bf16 v[108:111], v[120:123], v[140:143], 0
  v_mfma_f32_16x16x32_bf16 v[112:115], v[120:123], v[144:147], 0
  v_mfma_f32_16x16x32_bf16 v[116:119], v[120:123], v[148:151], 0
  s_waitcnt lgkmcnt(2)
  v_mfma_f32_16x16x32_bf16 v[104:107], v[124:127], v[8:11], v[104:107]
  v_mfma_f32_16x16x32_bf16 v[108:111], v[124:127], v[12:15], v[108:111]
  v_mfma_f32_16x16x32_bf16 v[112:115], v[124:127], v[16:19], v[112:115]
  v_mfma_f32_16x16x32_bf16 v[116:119], v[124:127], v[20:23], v[116:119]
  s_waitcnt lgkmcnt(1)
  v_mfma_f32_16x16x32_bf16 v[104:107], v[128:131], v[40:43], v[104:107]
  v_mfma_f32_16x16x32_bf16 v[108:111], v[128:131], v[44:47], v[108:111]
  v_mfma_f32_16x16x32_bf16 v[112:115], v[128:131], v[48:51], v[112:115]
  v_mfma_f32_16x16x32_bf16 v[116:119], v[128:131], v[52:55], v[116:119]
  s_waitcnt lgkmcnt(0)
  v_mfma_f32_16x16x32_bf16 v[104:107], v[132:135], v[72:75], v[104:107]
  v_mfma_f32_16x16x32_bf16 v[108:111], v[132:135], v[76:79], v[108:111]
  v_mfma_f32_16x16x32_bf16 v[112:115], v[132:135], v[80:83], v[112:115]
  v_mfma_f32_16x16x32_bf16 v[116:119], v[132:135], v[84:87], v[116:119]
  v_mfma_f32_16x16x32_bf16 v[136:139], v[120:123], v[152:155], 0
  v_mfma_f32_16x16x32_bf16 v[140:143], v[120:123], v[156:159], 0
  v_mfma_f32_16x16x32_bf16 v[144:147], v[120:123], v[160:163], 0
  v_mfma_f32_16x16x32_bf16 v[148:151], v[120:123], v[164:167], 0
  v_mfma_f32_16x16x32_bf16 v[136:139], v[124:127], v[24:27], v[136:139]
  v_mfma_f32_16x16x32_bf16 v[140:143], v[124:127], v[28:31], v[140:143]
  v_mfma_f32_16x16x32_bf16 v[144:147], v[124:127], v[32:35], v[144:147]
  v_mfma_f32_16x16x32_bf16 v[148:151], v[124:127], v[36:39], v[148:151]
  v_mfma_f32_16x16x32_bf16 v[136:139], v[128:131], v[56:59], v[136:139]
  v_mfma_f32_16x16x32_bf16 v[140:143], v[128:131], v[60:63], v[140:143]
  v_mfma_f32_16x16x32_bf16 v[144:147], v[128:131], v[64:67], v[144:147]
  v_mfma_f32_16x16x32_bf16 v[148:151], v[128:131], v[68:71], v[148:151]
  v_mfma_f32_16x16x32_bf16 v[136:139], v[132:135], v[88:91], v[136:139]
  v_mfma_f32_16x16x32_bf16 v[140:143], v[132:135], v[92:95], v[140:143]
  v_mfma_f32_16x16x32_bf16 v[144:147], v[132:135], v[96:99], v[144:147]
  v_mfma_f32_16x16x32_bf16 v[148:151], v[132:135], v[100:103], v[148:151]
L_ms_39:
  v_cndmask_b32 v120, v104, v112, s[72:73]
  s_nop 3
  v_cndmask_b32 v120, v120, v136, s[74:75]
  s_nop 0
  v_cndmask_b32 v120, v120, v144, s[82:83]
  v_mov_b32 v121, s4
  v_cndmask_b32 v122, v108, v116, s[72:73]
  v_cndmask_b32 v122, v122, v140, s[74:75]
  v_cndmask_b32 v122, v122, v148, s[82:83]
  v_mov_b32 v123, s4
  v_cndmask_b32 v124, v105, v113, s[72:73]
  v_cndmask_b32 v124, v124, v137, s[74:75]
  v_cndmask_b32 v124, v124, v145, s[82:83]
  v_mov_b32 v125, s4
  v_cndmask_b32 v126, v109, v117, s[72:73]
  v_cndmask_b32 v126, v126, v141, s[74:75]
  v_cndmask_b32 v126, v126, v149, s[82:83]
  v_mov_b32 v127, s4
  s_cbranch_execz L_st_40
  buffer_store_dwordx4 v[120:123], v7, s[16:19], s80 offen offset:0 sc1
L_st_40:
  s_cbranch_execz L_st_41
  buffer_store_dwordx4 v[124:127], v7, s[16:19], s81 offen offset:0 sc1
L_st_41:
  s_cbranch_execz L_dryret
  s_branch L_end
L_s1c:
  s_lshl_b32 s6, s25, 4
  s_add_u32 s6, s6, s24
  s_sub_u32 s6, s6, 48
  s_lshl_b32 s80, s6, 15
  s_lshr_b32 s64, s3, 1
  s_lshl_b32 s64, s64, 13
  s_add_u32 s80, s80, s64
  s_and_b32 s64, s3, 1
  s_lshl_b32 s64, s64, 6
  s_add_u32 s80, s80, s64
  s_add_u32 s80, s80, 0x300000
  s_add_u32 s81, s80, 4096
  s_lshl_b32 s78, s6, 10
  s_add_u32 s78, s78, 0x290000
  v_lshrrev_b32 v5, 2, v0
  v_lshlrev_b32 v6, 2, v5
  v_lshlrev_b32 v5, 7, v5
  v_and_b32 v7, 3, v0
  v_lshl_add_u32 v5, v7, 4, v5
  v_lshlrev_b32 v7, 2, v7
  s_lshl_b32 s64, s3, 4
  v_add_u32 v7, s64, v7
  s_mov_b32 s68, 0
L_w_42:
  s_add_u32 s68, s68, 1
  s_cmp_gt_u32 s68, 0x400000
  s_cbranch_scc1 L_fail
  ds_read_b32 v4, v3 offset:40
  s_waitcnt lgkmcnt(0)
  v_readfirstlane_b32 s67, v4
  s_nop 0
  s_cmp_ge_u32 s67, 8
  s_cbranch_execz L_wd_43
  s_cbranch_scc0 L_w_42
L_wd_43:
  s_mov_b32 s68, 0
L_p_44:
  s_add_u32 s68, s68, 1
  s_cmp_gt_u32 s68, 0x40000
  s_cbranch_scc1 L_fail
  s_cbranch_execz L_ps_45
  buffer_load_dwordx4 v[24:27], v2, s[16:19], s78 offen offset:0 sc1
  buffer_load_dwordx4 v[8:11], v5, s[16:19], s80 offen offset:0 sc1
  buffer_load_dwordx4 v[12:15], v5, s[16:19], s80 offen offset:2048 sc1
  buffer_load_dwordx4 v[16:19], v5, s[16:19], s81 offen offset:0 sc1
  buffer_load_dwordx4 v[20:23], v5, s[16:19], s81 offen offset:2048 sc1
  s_waitcnt vmcnt(4)
L_ps_45:
  s_mov_b64 s[70:71], -1
  v_cmp_eq_u32 vcc, s4, v25
  v_cmp_eq_u32 s[76:77], s4, v27
  s_and_b64 s[70:71], s[70:71], vcc
  s_and_b64 s[70:71], s[70:71], s[76:77]
  s_cbranch_execz L_vw_46
  s_waitcnt vmcnt(3)
L_vw_46:
  v_cmp_eq_u32 vcc, s4, v9
  v_cmp_eq_u32 s[76:77], s4, v11
  s_and_b64 s[70:71], s[70:71], vcc
  s_and_b64 s[70:71], s[70:71], s[76:77]
  s_cbranch_execz L_vw_47
  s_waitcnt vmcnt(2)
L_vw_47:
  v_cmp_eq_u32 vcc, s4, v13
  v_cmp_eq_u32 s[76:77], s4, v15
  s_and_b64 s[70:71], s[70:71], vcc
  s_and_b64 s[70:71], s[70:71], s[76:77]
  s_cbranch_execz L_vw_48
  s_waitcnt vmcnt(1)
L_vw_48:
  v_cmp_eq_u32 vcc, s4, v17
  v_cmp_eq_u32 s[76:77], s4, v19
  s_and_b64 s[70:71], s[70:71], vcc
  s_and_b64 s[70:71], s[70:71], s[76:77]
  s_cbranch_execz L_vw_49
  s_waitcnt vmcnt(0)
L_vw_49:
  v_cmp_eq_u32 vcc, s4, v21
  v_cmp_eq_u32 s[76:77], s4, v23
  s_and_b64 s[70:71], s[70:71], vcc
  s_and_b64 s[70:71], s[70:71], s[76:77]
  s_cmp_eq_u64 s[70:71], -1
  s_cbranch_execz L_pd_50
  s_cbranch_scc0 L_p_44
L_pd_50:
  v_mov_b32 v28, v24
  s_nop 1
  v_max_f32_dpp v28, v28, v28 quad_perm:[1,0,3,2] row_mask:0xf bank_mask:0xf
  s_nop 1
  v_max_f32_dpp v28, v28, v28 quad_perm:[2,3,0,1] row_mask:0xf bank_mask:0xf
  s_nop 1
  v_max_f32_dpp v28, v28, v28 row_half_mirror row_mask:0xf bank_mask:0xf
  s_nop 1
  v_max_f32_dpp v28, v28, v28 row_ror:8 row_mask:0xf bank_mask:0xf
  v_mov_b32 v31, v28
  s_nop 1
  v_permlane16_swap_b32 v28, v31
  v_max_f32 v28, v28, v31
  v_mov_b32 v31, v28
  s_nop 1
  v_permlane32_swap_b32 v28, v31
  v_max_f32 v28, v28, v31
  v_sub_f32 v29, v24, v28
  v_mul_f32 v29, s79, v29
  v_exp_f32 v29, v29
  s_nop 0
  ds_bpermute_b32 v32, v6, v29 offset:0
  ds_bpermute_b32 v33, v6, v29 offset:64
  ds_bpermute_b32 v34, v6, v29 offset:128
  ds_bpermute_b32 v35, v6, v29 offset:192
  v_mul_f32 v30, v26, v29
  s_nop 1
  v_add_f32_dpp v30, v30, v30 quad_perm:[1,0,3,2] row_mask:0xf bank_mask:0xf
  s_nop 1
  v_add_f32_dpp v30, v30, v30 quad_perm:[2,3,0,1] row_mask:0xf bank_mask:0xf
  s_nop 1
  v_add_f32_dpp v30, v30, v30 row_half_mirror row_mask:0xf bank_mask:0xf
  s_nop 1
  v_add_f32_dpp v30, v30, v30 row_ror:8 row_mask:0xf bank_mask:0xf
  v_mov_b32 v31, v30
  s_nop 1
  v_permlane16_swap_b32 v30, v31
  v_add_f32 v30, v30, v31
  v_mov_b32 v31, v30
  s_nop 1
  v_permlane32_swap_b32 v30, v31
  v_add_f32 v30, v30, v31
  v_rcp_f32 v28, v30
  s_waitcnt lgkmcnt(0)
  v_mul_f32 v36, v8, v32
  v_mul_f32 v37, v10, v32
  v_fmac_f32 v36, v12, v33
  v_fmac_f32 v37, v14, v33
  v_fmac_f32 v36, v16, v34
  v_fmac_f32 v37, v18, v34
  v_fmac_f32 v36, v20, v35
  v_fmac_f32 v37, v22, v35
  s_nop 0
  v_add_f32_dpp v36, v36, v36 row_ror:4 row_mask:0xf bank_mask:0xf
  v_add_f32_dpp v37, v37, v37 row_ror:4 row_mask:0xf bank_mask:0xf
  s_nop 0
  v_add_f32_dpp v36, v36, v36 row_ror:8 row_mask:0xf bank_mask:0xf
  v_add_f32_dpp v37, v37, v37 row_ror:8 row_mask:0xf bank_mask:0xf
  v_mov_b32 v38, v36
  v_mov_b32 v39, v37
  s_nop 0
  v_permlane16_swap_b32 v36, v38
  v_permlane16_swap_b32 v37, v39
  v_add_f32 v36, v36, v38
  v_add_f32 v37, v37, v39
  v_mov_b32 v38, v36
  v_mov_b32 v39, v37
  s_nop 0
  v_permlane32_swap_b32 v36, v38
  v_permlane32_swap_b32 v37, v39
  v_add_f32 v36, v36, v38
  v_add_f32 v37, v37, v39
  v_mul_f32 v38, v36, v28
  v_fma_f32 v39, -v38, v30, v36
  v_fma_f32 v36, v39, v28, v38
  v_mul_f32 v38, v37, v28
  v_fma_f32 v39, -v38, v30, v37
  v_fma_f32 v37, v39, v28, v38
  v_cvt_pk_bf16_f32 v36, v36, v37
  s_and_b64 exec, s[26:27], 0xf
  ds_write_b32 v7, v36 offset:5952
  s_mov_b64 exec, s[26:27]
  s_branch L_end
L_role:
  s_setprio 2
  s_sub_u32 s5, s3, 8
  v_lshlrev_b32 v4, 2, v0
  ds_write_b32 v4, v3
  v_mov_b32 v8, -1
  v_mov_b32 v9, -1
  v_mov_b32 v10, -1
  v_mov_b32 v11, -1
  ds_write_b128 v2, v[8:11] offset:4352
  ds_write_b128 v2, v[8:11] offset:5376
  s_waitcnt lgkmcnt(0)
  s_load_dword s4, s[60:61], 0
  s_mov_b32 s16, s60
  s_and_b32 s17, s61, 0xffff
  s_mov_b32 s18, 0x10000000
  s_mov_b32 s19, 0x20000
  s_barrier
  s_mov_b32 s28, s56
  s_and_b32 s29, s57, 0xffff
  s_mov_b32 s30, 0x800
  s_mov_b32 s31, 0x20000
  s_mov_b32 s100, 0
  v_mov_b32 v16, 0
  v_mov_b32 v17, 0
  v_mov_b32 v18, 0
  v_mov_b32 v20, 0
  s_cmp_lt_u32 s24, 8
  s_cbranch_scc1 L_mod
  s_cmp_lt_u32 s24, 24
  s_cbranch_scc1 L_p1a
  s_cmp_lt_u32 s24, 28
  s_cbranch_scc1 L_p1b
  s_cmp_lt_u32 s24, 32
  s_cbranch_scc1 L_mod
  s_cmp_lt_u32 s24, 48
  s_cbranch_scc1 L_p2
L_p1a:
  s_sub_u32 s64, s24, 8
  s_sub_u32 s65, s24, 32
  s_cmp_ge_u32 s24, 48
  s_cselect_b32 s6, s65, s64
  s_lshl_b32 s64, s25, 9
  v_lshlrev_b32 v4, 3, v0
  v_add_u32 v4, s64, v4
  global_load_dwordx2 v[6:7], v4, s[52:53]
  s_mov_b32 s20, s54
  s_and_b32 s21, s55, 0xffff
  s_mov_b32 s22, 0xc00000
  s_mov_b32 s23, 0x20000
  v_lshrrev_b32 v1, 3, v0
  v_mul_u32_u24 v1, 98304, v1
  v_and_b32 v4, 7, v0
  v_lshl_add_u32 v1, v4, 4, v1
  s_lshl_b32 s64, s25, 2
  s_add_u32 s64, s64, s5
  s_mul_i32 s7, s64, 786432
  s_lshl_b32 s65, s6, 7
  s_add_u32 s7, s7, s65
  s_add_u32 s64, s7, 0x0
  buffer_load_dwordx4 v[8:11], v1, s[20:23], s64 offen nt
  s_add_u32 s64, s7, 0x3000
  buffer_load_dwordx4 v[12:15], v1, s[20:23], s64 offen nt
  s_add_u32 s64, s7, 0x6000
  buffer_load_dwordx4 v[16:19], v1, s[20:23], s64 offen nt
  s_add_u32 s64, s7, 0x9000
  buffer_load_dwordx4 v[20:23], v1, s[20:23], s64 offen nt
  s_add_u32 s64, s7, 0xc000
  buffer_load_dwordx4 v[24:27], v1, s[20:23], s64 offen nt
  s_add_u32 s64, s7, 0xf000
  buffer_load_dwordx4 v[28:31], v1, s[20:23], s64 offen nt
  s_add_u32 s64, s7, 0x12000
  buffer_load_dwordx4 v[32:35], v1, s[20:23], s64 offen nt
  s_add_u32 s64, s7, 0x15000
  buffer_load_dwordx4 v[36:39], v1, s[20:23], s64 offen nt
  s_waitcnt lgkmcnt(0)
  s_add_u32 s4, s4, 1
  s_waitcnt vmcnt(8)
  v_lshlrev_b32 v136, 16, v6
  v_and_b32 v137, 0xffff0000, v6
  v_lshlrev_b32 v138, 16, v7
  v_and_b32 v139, 0xffff0000, v7
  s_mov_b32 s79, 0x3fb8aa3b
  v_mul_f32 v140, s79, -v136
  v_mul_f32 v141, s79, -v137
  v_mul_f32 v142, s79, -v138
  v_mul_f32 v143, s79, -v139
  v_min_f32 v140, 0x42f00000, v140
  v_min_f32 v141, 0x42f00000, v141
  v_min_f32 v142, 0x42f00000, v142
  v_min_f32 v143, 0x42f00000, v143
  v_exp_f32 v140, v140
  v_exp_f32 v141, v141
  v_exp_f32 v142, v142
  v_exp_f32 v143, v143
  v_add_f32 v140, 1.0, v140
  v_add_f32 v141, 1.0, v141
  v_add_f32 v142, 1.0, v142
  v_add_f32 v143, 1.0, v143
  v_rcp_f32 v144, v140
  v_rcp_f32 v145, v141
  v_rcp_f32 v146, v142
  v_rcp_f32 v147, v143
  v_mul_f32 v148, v136, v144
  v_fma_f32 v149, -v148, v140, v136
  v_fma_f32 v136, v149, v144, v148
  v_mul_f32 v148, v137, v145
  v_fma_f32 v149, -v148, v141, v137
  v_fma_f32 v137, v149, v145, v148
  v_mul_f32 v148, v138, v146
  v_fma_f32 v149, -v148, v142, v138
  v_fma_f32 v138, v149, v146, v148
  v_mul_f32 v148, v139, v147
  v_fma_f32 v149, -v148, v143, v139
  v_fma_f32 v139, v149, v147, v148
  v_cvt_pk_bf16_f32 v6, v136, v137
  v_cvt_pk_bf16_f32 v7, v138, v139
  s_lshl_b32 s64, s5, 9
  s_add_u32 s64, s64, 2304
  v_lshlrev_b32 v4, 3, v0
  v_add_u32 v4, s64, v4
  ds_write_b64 v4, v[6:7]
  v_lshrrev_b32 v1, 4, v0
  v_lshlrev_b32 v1, 5, v1
  v_and_b32 v4, 1, v0
  v_lshl_add_u32 v1, v4, 4, v1
  s_lshl_b32 s64, s5, 9
  s_add_u32 s64, s64, 2304
  v_add_u32 v1, s64, v1
  s_lshl_b32 s64, s5, 7
  v_add_u32 v1, s64, v1
  s_and_b32 s80, s6, 15
  s_lshl_b32 s80, s80, 12
  s_lshr_b32 s64, s6, 4
  s_lshl_b32 s64, s64, 11
  s_add_u32 s80, s80, s64
  s_lshl_b32 s64, s25, 9
  s_add_u32 s80, s80, s64
  s_add_u32 s80, s80, 0x2a0000
  v_lshlrev_b32 v7, 5, v0
  s_add_u32 s81, s5, 8
  s_mov_b32 s78, 2048
  s_cbranch_execz L_vw_51
  s_waitcnt vmcnt(0)
L_vw_51:
  v_mov_b32 v4, 1
  s_waitcnt lgkmcnt(0)
  s_and_b64 exec, s[26:27], 0x1
  ds_add_u32 v3, v4 offset:28
  s_mov_b64 exec, s[26:27]
  v_perm_b32 v136, v12, v8, s62
  v_perm_b32 v137, v20, v16, s62
  v_perm_b32 v138, v28, v24, s62
  v_perm_b32 v139, v36, v32, s62
  v_perm_b32 v140, v12, v8, s63
  v_perm_b32 v141, v20, v16, s63
  v_perm_b32 v142, v28, v24, s63
  v_perm_b32 v143, v36, v32, s63
  v_perm_b32 v144, v13, v9, s62
  v_perm_b32 v145, v21, v17, s62
  v_perm_b32 v146, v29, v25, s62
  v_perm_b32 v147, v37, v33, s62
  v_perm_b32 v148, v13, v9, s63
  v_perm_b32 v149, v21, v17, s63
  v_perm_b32 v150, v29, v25, s63
  v_perm_b32 v151, v37, v33, s63
  v_perm_b32 v152, v14, v10, s62
  v_perm_b32 v153, v22, v18, s62
  v_perm_b32 v154, v30, v26, s62
  v_perm_b32 v155, v38, v34, s62
  v_perm_b32 v156, v14, v10, s63
  v_perm_b32 v157, v22, v18, s63
  v_perm_b32 v158, v30, v26, s63
  v_perm_b32 v159, v38, v34, s63
  v_perm_b32 v160, v15, v11, s62
  v_perm_b32 v161, v23, v19, s62
  v_perm_b32 v162, v31, v27, s62
  v_perm_b32 v163, v39, v35, s62
  v_perm_b32 v164, v15, v11, s63
  v_perm_b32 v165, v23, v19, s63
  v_perm_b32 v166, v31, v27, s63
  v_perm_b32 v167, v39, v35, s63
  ds_read_b128 v[120:123], v1 offset:0
  s_cbranch_execz L_ms_52
  s_waitcnt lgkmcnt(0)
  v_mfma_f32_16x16x32_bf16 v[104:107], v[120:123], v[136:139], 0
  v_mfma_f32_16x16x32_bf16 v[108:111], v[120:123], v[140:143], 0
  v_mfma_f32_16x16x32_bf16 v[112:115], v[120:123], v[144:147], 0
  v_mfma_f32_16x16x32_bf16 v[116:119], v[120:123], v[148:151], 0
  v_mfma_f32_16x16x32_bf16 v[136:139], v[120:123], v[152:155], 0
  v_mfma_f32_16x16x32_bf16 v[140:143], v[120:123], v[156:159], 0
  v_mfma_f32_16x16x32_bf16 v[144:147], v[120:123], v[160:163], 0
  v_mfma_f32_16x16x32_bf16 v[148:151], v[120:123], v[164:167], 0
L_ms_52:
  s_nop 0
  v_add_f32_dpp v120, v105, v104 row_ror:8 row_mask:0xf bank_mask:0xf
  v_add_f32_dpp v121, v109, v108 row_ror:8 row_mask:0xf bank_mask:0xf
  v_add_f32_dpp v122, v113, v112 row_ror:8 row_mask:0xf bank_mask:0xf
  v_add_f32_dpp v123, v117, v116 row_ror:8 row_mask:0xf bank_mask:0xf
  v_add_f32_dpp v124, v137, v136 row_ror:8 row_mask:0xf bank_mask:0xf
  v_add_f32_dpp v125, v141, v140 row_ror:8 row_mask:0xf bank_mask:0xf
  v_add_f32_dpp v126, v145, v144 row_ror:8 row_mask:0xf bank_mask:0xf
  v_add_f32_dpp v127, v149, v148 row_ror:8 row_mask:0xf bank_mask:0xf
  s_lshl_b32 s64, s81, 8
  v_lshlrev_b32 v5, 5, v0
  v_add_u32 v5, s64, v5
  s_and_b64 exec, s[26:27], 0xff
  ds_write_b128 v5, v[120:123] offset:4352
  ds_write_b128 v5, v[124:127] offset:4368
  s_mov_b64 exec, s[26:27]
  v_mov_b32 v4, 1
  s_waitcnt lgkmcnt(0)
  s_and_b64 exec, s[26:27], 0x1
  ds_add_u32 v3, v4 offset:8
  s_mov_b64 exec, s[26:27]
  s_cmp_lg_u32 s5, 0
  s_cbranch_scc1 L_p1a_done
  s_mov_b32 s68, 0
L_w_53:
  s_add_u32 s68, s68, 1
  s_cmp_gt_u32 s68, 0x400000
  s_cbranch_scc1 L_fail
  ds_read_b32 v4, v3 offset:8
  s_waitcnt lgkmcnt(0)
  v_readfirstlane_b32 s67, v4
  s_nop 0
  s_cmp_ge_u32 s67, 4
  s_cbranch_execz L_wd_54
  s_cbranch_scc0 L_w_53
L_wd_54:
  v_and_b32 v5, 15, v0
  v_lshlrev_b32 v5, 4, v5
  v_add_u32 v5, s78, v5
  ds_read_b128 v[16:19], v5 offset:4352
  ds_read_b128 v[20:23], v5 offset:4608
  ds_read_b128 v[24:27], v5 offset:4864
  ds_read_b128 v[28:31], v5 offset:5120
  s_waitcnt lgkmcnt(2)
  v_add_f32 v8, v16, v20
  v_add_f32 v9, v17, v21
  v_add_f32 v10, v18, v22
  v_add_f32 v11, v19, v23
  s_waitcnt lgkmcnt(1)
  v_add_f32 v8, v8, v24
  v_add_f32 v9, v9, v25
  v_add_f32 v10, v10, v26
  v_add_f32 v11, v11, v27
  s_waitcnt lgkmcnt(0)
  v_add_f32 v8, v8, v28
  v_add_f32 v9, v9, v29
  v_add_f32 v10, v10, v30
  v_add_f32 v11, v11, v31
  v_mov_b32 v32, v8
  v_mov_b32 v33, s4
  v_mov_b32 v34, v9
  v_mov_b32 v35, s4
  v_mov_b32 v36, v10
  v_mov_b32 v37, s4
  v_mov_b32 v38, v11
  v_mov_b32 v39, s4
  s_and_b64 exec, s[26:27], 0xffff
  s_cbranch_execz L_st_55
  buffer_store_dwordx4 v[32:35], v7, s[16:19], s80 offen offset:0 sc1
L_st_55:
  s_cbranch_execz L_st_56
  buffer_store_dwordx4 v[36:39], v7, s[16:19], s80 offen offset:16 sc1
L_st_56:
  s_mov_b64 exec, s[26:27]
L_p1a_done:
  s_cmp_ge_u32 s24, 48
  s_cbranch_scc1 L_s1
  s_cmp_lt_u32 s24, 22
  s_cbranch_scc1 L_s3
  s_branch L_warm_stream
L_p1b:
  s_lshl_b32 s6, s25, 2
  s_add_u32 s6, s6, s24
  s_sub_u32 s6, s6, 24
  v_lshlrev_b32 v4, 5, v0
  global_load_dwordx4 v[136:139], v4, s[32:33]
  global_load_dwordx4 v[140:143], v4, s[32:33] offset:16
  s_lshl_b32 s64, s6, 7
  v_and_b32 v4, 31, v0
  v_lshlrev_b32 v4, 2, v4
  v_add_u32 v4, s64, v4
  global_load_dword v6, v4, s[32:33]
  s_lshl_b32 s64, s25, 11
  s_add_u32 s64, s64, 0x2b0000
  v_lshlrev_b32 v4, 8, v0
  s_and_b64 exec, s[26:27], 0xff
  buffer_store_dword v3, v4, s[16:19], s64 offen sc0 sc1
  s_mov_b64 exec, s[26:27]
  s_waitcnt lgkmcnt(0)
  s_add_u32 s4, s4, 1
  s_waitcnt vmcnt(0)
  v_lshlrev_b32 v144, 16, v136
  v_and_b32 v145, 0xffff0000, v136
  v_lshlrev_b32 v146, 16, v137
  v_and_b32 v147, 0xffff0000, v137
  v_lshlrev_b32 v148, 16, v138
  v_and_b32 v149, 0xffff0000, v138
  v_lshlrev_b32 v150, 16, v139
  v_and_b32 v151, 0xffff0000, v139
  v_lshlrev_b32 v152, 16, v140
  v_and_b32 v153, 0xffff0000, v140
  v_lshlrev_b32 v154, 16, v141
  v_and_b32 v155, 0xffff0000, v141
  v_lshlrev_b32 v156, 16, v142
  v_and_b32 v157, 0xffff0000, v142
  v_lshlrev_b32 v158, 16, v143
  v_and_b32 v159, 0xffff0000, v143
  v_add_f32 v160, v144, v145
  v_mul_f32 v161, v144, v144
  v_fmac_f32 v161, v145, v145
  v_add_f32 v160, v160, v146
  v_fmac_f32 v161, v146, v146
  v_add_f32 v160, v160, v147
  v_fmac_f32 v161, v147, v147
  v_add_f32 v160, v160, v148
  v_fmac_f32 v161, v148, v148
  v_add_f32 v160, v160, v149
  v_fmac_f32 v161, v149, v149
  v_add_f32 v160, v160, v150
  v_fmac_f32 v161, v150, v150
  v_add_f32 v160, v160, v151
  v_fmac_f32 v161, v151, v151
  v_add_f32 v160, v160, v152
  v_fmac_f32 v161, v152, v152
  v_add_f32 v160, v160, v153
  v_fmac_f32 v161, v153, v153
  v_add_f32 v160, v160, v154
  v_fmac_f32 v161, v154, v154
  v_add_f32 v160, v160, v155
  v_fmac_f32 v161, v155, v155
  v_add_f32 v160, v160, v156
  v_fmac_f32 v161, v156, v156
  v_add_f32 v160, v160, v157
  v_fmac_f32 v161, v157, v157
  v_add_f32 v160, v160, v158
  v_fmac_f32 v161, v158, v158
  v_add_f32 v160, v160, v159
  v_fmac_f32 v161, v159, v159
  s_nop 0
  v_add_f32_dpp v160, v160, v160 quad_perm:[1,0,3,2] row_mask:0xf bank_mask:0xf
  v_add_f32_dpp v161, v161, v161 quad_perm:[1,0,3,2] row_mask:0xf bank_mask:0xf
  s_nop 0
  v_add_f32_dpp v160, v160, v160 quad_perm:[2,3,0,1] row_mask:0xf bank_mask:0xf
  v_add_f32_dpp v161, v161, v161 quad_perm:[2,3,0,1] row_mask:0xf bank_mask:0xf
  s_nop 0
  v_add_f32_dpp v160, v160, v160 row_half_mirror row_mask:0xf bank_mask:0xf
  v_add_f32_dpp v161, v161, v161 row_half_mirror row_mask:0xf bank_mask:0xf
  s_nop 0
  v_add_f32_dpp v160, v160, v160 row_ror:8 row_mask:0xf bank_mask:0xf
  v_add_f32_dpp v161, v161, v161 row_ror:8 row_mask:0xf bank_mask:0xf
  v_mov_b32 v162, v160
  v_mov_b32 v163, v161
  s_nop 0
  v_permlane16_swap_b32 v160, v162
  v_permlane16_swap_b32 v161, v163
  v_add_f32 v160, v160, v162
  v_add_f32 v161, v161, v163
  v_mov_b32 v162, v160
  v_mov_b32 v163, v161
  s_nop 0
  v_permlane32_swap_b32 v160, v162
  v_permlane32_swap_b32 v161, v163
  v_add_f32 v160, v160, v162
  v_add_f32 v161, v161, v163
  v_mul_f32 v164, 0x3a800000, v160
  v_mul_f32 v165, 0x3a800000, v161
  v_fma_f32 v165, -v164, v164, v165
  v_max_f32 v165, 0, v165
  v_cvt_pk_bf16_f32 v167, v164, v165
  v_lshlrev_b32 v164, 16, v167
  v_and_b32 v165, 0xffff0000, v167
  v_add_f32 v165, 0x3727c5ac, v165
  v_cvt_pk_bf16_f32 v165, v165, v165
  v_and_b32 v165, 0xffff0000, v165
  v_sqrt_f32 v165, v165
  s_nop 0
  v_cvt_pk_bf16_f32 v165, v165, v165
  v_and_b32 v165, 0xffff0000, v165
  v_rcp_f32 v166, v165
  v_lshlrev_b32 v136, 16, v6
  v_and_b32 v137, 0xffff0000, v6
  v_sub_f32 v136, v136, v164
  v_sub_f32 v137, v137, v164
  v_cvt_pk_bf16_f32 v140, v136, v137
  v_lshlrev_b32 v136, 16, v140
  v_and_b32 v137, 0xffff0000, v140
  v_mul_f32 v140, v136, v166
  v_fma_f32 v141, -v140, v165, v136
  v_fma_f32 v136, v141, v166, v140
  v_mul_f32 v140, v137, v166
  v_fma_f32 v141, -v140, v165, v137
  v_fma_f32 v137, v141, v166, v140
  v_cvt_pk_bf16_f32 v140, v136, v137
  v_lshlrev_b32 v136, 16, v140
  v_and_b32 v137, 0xffff0000, v140
  s_lshl_b32 s80, s6, 12
  s_add_u32 s80, s80, 0x2a0000
  v_and_b32 v5, 15, v0
  v_lshlrev_b32 v6, 3, v5
  v_lshlrev_b32 v5, 4, v5
  v_lshrrev_b32 v7, 4, v0
  v_lshl_add_u32 v7, v7, 12, v5
  s_lshl_b32 s81, s5, 16
  s_lshl_b32 s64, s6, 8
  s_add_u32 s81, s81, s64
  s_add_u32 s81, s81, 0x10000
  v_mov_b32 v121, s4
  v_mov_b32 v123, s4
  s_mov_b32 s68, 0
L_p_57:
  s_add_u32 s68, s68, 1
  s_cmp_gt_u32 s68, 0x40000
  s_cbranch_scc1 L_fail
  s_cbranch_execz L_ps_58
  buffer_load_dwordx4 v[104:107], v2, s[16:19], s80 offen offset:0 sc1
  buffer_load_dwordx4 v[108:111], v2, s[16:19], s80 offen offset:1024 sc1
  buffer_load_dwordx4 v[112:115], v2, s[16:19], s80 offen offset:2048 sc1
  buffer_load_dwordx4 v[116:119], v2, s[16:19], s80 offen offset:3072 sc1
  s_waitcnt vmcnt(3)
L_ps_58:
  s_mov_b64 s[70:71], -1
  v_cmp_eq_u32 vcc, s4, v105
  v_cmp_eq_u32 s[76:77], s4, v107
  s_and_b64 s[70:71], s[70:71], vcc
  s_and_b64 s[70:71], s[70:71], s[76:77]
  s_cbranch_execz L_vw_59
  s_waitcnt vmcnt(2)
L_vw_59:
  v_cmp_eq_u32 vcc, s4, v109
  v_cmp_eq_u32 s[76:77], s4, v111
  s_and_b64 s[70:71], s[70:71], vcc
  s_and_b64 s[70:71], s[70:71], s[76:77]
  s_cbranch_execz L_vw_60
  s_waitcnt vmcnt(1)
L_vw_60:
  v_cmp_eq_u32 vcc, s4, v113
  v_cmp_eq_u32 s[76:77], s4, v115
  s_and_b64 s[70:71], s[70:71], vcc
  s_and_b64 s[70:71], s[70:71], s[76:77]
  s_cbranch_execz L_vw_61
  s_waitcnt vmcnt(0)
L_vw_61:
  v_cmp_eq_u32 vcc, s4, v117
  v_cmp_eq_u32 s[76:77], s4, v119
  s_and_b64 s[70:71], s[70:71], vcc
  s_and_b64 s[70:71], s[70:71], s[76:77]
  s_cmp_eq_u64 s[70:71], -1
  s_cbranch_execz L_pd_62
  s_cbranch_scc0 L_p_57
L_pd_62:
  v_add_f32 v104, v104, v108
  v_add_f32 v105, v106, v110
  v_add_f32 v106, v112, v116
  v_add_f32 v107, v114, v118
  v_mov_b32 v108, v104
  v_mov_b32 v109, v105
  v_mov_b32 v110, v106
  v_mov_b32 v111, v107
  v_permlane32_swap_b32 v104, v108
  v_permlane32_swap_b32 v105, v109
  v_permlane32_swap_b32 v106, v110
  v_permlane32_swap_b32 v107, v111
  v_add_f32 v104, v104, v108
  v_add_f32 v105, v105, v109
  v_add_f32 v106, v106, v110
  v_add_f32 v107, v107, v111
  v_cvt_pk_bf16_f32 v108, v104, v105
  v_lshlrev_b32 v104, 16, v108
  v_and_b32 v105, 0xffff0000, v108
  v_cvt_pk_bf16_f32 v109, v106, v107
  v_lshlrev_b32 v106, 16, v109
  v_and_b32 v107, 0xffff0000, v109
  v_add_f32 v106, 1.0, v106
  v_add_f32 v107, 1.0, v107
  v_cvt_pk_bf16_f32 v109, v106, v107
  v_lshlrev_b32 v106, 16, v109
  v_and_b32 v107, 0xffff0000, v109
  v_mul_f32 v106, v106, v136
  v_mul_f32 v107, v107, v137
  v_cvt_pk_bf16_f32 v109, v106, v107
  v_lshlrev_b32 v106, 16, v109
  v_and_b32 v107, 0xffff0000, v109
  v_add_f32 v104, v104, v106
  v_add_f32 v105, v105, v107
  v_cvt_pk_bf16_f32 v104, v104, v105
  ds_bpermute_b32 v120, v6, v104
  ds_bpermute_b32 v122, v6, v104 offset:4
  s_waitcnt lgkmcnt(0)
  s_add_u32 s65, s81, 0x0
  s_cbranch_execz L_st_63
  buffer_store_dwordx4 v[120:123], v7, s[16:19], s65 offen offset:0 sc1
L_st_63:
  s_add_u32 s65, s81, 0x4000
  s_cbranch_execz L_st_64
  buffer_store_dwordx4 v[120:123], v7, s[16:19], s65 offen offset:0 sc1
L_st_64:
  s_add_u32 s65, s81, 0x8000
  s_cbranch_execz L_st_65
  buffer_store_dwordx4 v[120:123], v7, s[16:19], s65 offen offset:0 sc1
L_st_65:
  s_add_u32 s65, s81, 0xc000
  s_cbranch_execz L_st_66
  buffer_store_dwordx4 v[120:123], v7, s[16:19], s65 offen offset:0 sc1
L_st_66:
  s_branch L_mod2
L_mod:
  s_waitcnt lgkmcnt(0)
  s_add_u32 s4, s4, 1
L_mod2:
  s_lshl_b32 s64, s25, 3
  s_add_u32 s64, s64, s24
  s_add_u32 s65, s64, 32
  s_add_u32 s64, s64, 40
  s_cmp_ge_u32 s24, 24
  s_cselect_b32 s6, s64, s65
  s_mov_b32 s68, 0
L_w_67:
  s_sleep 2
  s_add_u32 s68, s68, 1
  s_cmp_gt_u32 s68, 0x400000
  s_cbranch_scc1 L_fail
  ds_read_b32 v4, v3 offset:36
  s_waitcnt lgkmcnt(0)
  v_readfirstlane_b32 s67, v4
  s_nop 0
  s_cmp_ge_u32 s67, 8
  s_cbranch_execz L_wd_68
  s_cbranch_scc0 L_w_67
L_wd_68:
  s_lshl_b32 s64, s5, 9
  v_lshlrev_b32 v4, 3, v0
  v_add_u32 v4, s64, v4
  global_load_dwordx2 v[6:7], v4, s[52:53]
  s_lshl_b32 s65, s6, 7
  s_mov_b32 s20, s54
  s_and_b32 s21, s55, 0xffff
  s_mov_b32 s22, 0xc00000
  s_mov_b32 s23, 0x20000
  v_lshrrev_b32 v1, 3, v0
  v_mul_u32_u24 v1, 98304, v1
  v_and_b32 v4, 7, v0
  v_lshl_add_u32 v1, v4, 4, v1
  s_mul_i32 s7, s5, 3145728
  s_add_u32 s7, s7, s65
  s_add_u32 s64, s7, 0x0
  buffer_load_dwordx4 v[8:11], v1, s[20:23], s64 offen nt
  s_add_u32 s64, s7, 0x3000
  buffer_load_dwordx4 v[12:15], v1, s[20:23], s64 offen nt
  s_add_u32 s64, s7, 0x6000
  buffer_load_dwordx4 v[16:19], v1, s[20:23], s64 offen nt
  s_add_u32 s64, s7, 0x9000
  buffer_load_dwordx4 v[20:23], v1, s[20:23], s64 offen nt
  s_add_u32 s64, s7, 0xc000
  buffer_load_dwordx4 v[24:27], v1, s[20:23], s64 offen nt
  s_add_u32 s64, s7, 0xf000
  buffer_load_dwordx4 v[28:31], v1, s[20:23], s64 offen nt
  s_add_u32 s64, s7, 0x12000
  buffer_load_dwordx4 v[32:35], v1, s[20:23], s64 offen nt
  s_add_u32 s64, s7, 0x15000
  buffer_load_dwordx4 v[36:39], v1, s[20:23], s64 offen nt
  s_add_u32 s64, s7, 0xc0000
  buffer_load_dwordx4 v[40:43], v1, s[20:23], s64 offen nt
  s_add_u32 s64, s7, 0xc3000
  buffer_load_dwordx4 v[44:47], v1, s[20:23], s64 offen nt
  s_add_u32 s64, s7, 0xc6000
  buffer_load_dwordx4 v[48:51], v1, s[20:23], s64 offen nt
  s_add_u32 s64, s7, 0xc9000
  buffer_load_dwordx4 v[52:55], v1, s[20:23], s64 offen nt
  s_add_u32 s64, s7, 0xcc000
  buffer_load_dwordx4 v[56:59], v1, s[20:23], s64 offen nt
  s_add_u32 s64, s7, 0xcf000
  buffer_load_dwordx4 v[60:63], v1, s[20:23], s64 offen nt
  s_add_u32 s64, s7, 0xd2000
  buffer_load_dwordx4 v[64:67], v1, s[20:23], s64 offen nt
  s_add_u32 s64, s7, 0xd5000
  buffer_load_dwordx4 v[68:71], v1, s[20:23], s64 offen nt
  s_add_u32 s64, s7, 0x180000
  s_waitcnt vmcnt(15)
  buffer_load_dwordx4 v[72:75], v1, s[20:23], s64 offen nt
  s_add_u32 s64, s7, 0x183000
  s_waitcnt vmcnt(15)
  buffer_load_dwordx4 v[76:79], v1, s[20:23], s64 offen nt
  s_add_u32 s64, s7, 0x186000
  s_waitcnt vmcnt(15)
  buffer_load_dwordx4 v[80:83], v1, s[20:23], s64 offen nt
  s_add_u32 s64, s7, 0x189000
  s_waitcnt vmcnt(15)
  buffer_load_dwordx4 v[84:87], v1, s[20:23], s64 offen nt
  s_add_u32 s64, s7, 0x18c000
  s_waitcnt vmcnt(15)
  buffer_load_dwordx4 v[88:91], v1, s[20:23], s64 offen nt
  s_add_u32 s64, s7, 0x18f000
  s_waitcnt vmcnt(15)
  buffer_load_dwordx4 v[92:95], v1, s[20:23], s64 offen nt
  s_add_u32 s64, s7, 0x192000
  s_waitcnt vmcnt(15)
  buffer_load_dwordx4 v[96:99], v1, s[20:23], s64 offen nt
  s_add_u32 s64, s7, 0x195000
  s_waitcnt vmcnt(15)
  buffer_load_dwordx4 v[100:103], v1, s[20:23], s64 offen nt
  s_add_u32 s64, s7, 0x240000
  s_waitcnt vmcnt(15)
  buffer_load_dwordx4 v[104:107], v1, s[20:23], s64 offen nt
  s_add_u32 s64, s7, 0x243000
  s_waitcnt vmcnt(15)
  buffer_load_dwordx4 v[108:111], v1, s[20:23], s64 offen nt
  s_add_u32 s64, s7, 0x246000
  s_waitcnt vmcnt(15)
  buffer_load_dwordx4 v[112:115], v1, s[20:23], s64 offen nt
  s_add_u32 s64, s7, 0x249000
  s_waitcnt vmcnt(15)
  buffer_load_dwordx4 v[116:119], v1, s[20:23], s64 offen nt
  s_add_u32 s64, s7, 0x24c000
  s_waitcnt vmcnt(15)
  buffer_load_dwordx4 v[120:123], v1, s[20:23], s64 offen nt
  s_add_u32 s64, s7, 0x24f000
  s_waitcnt vmcnt(15)
  buffer_load_dwordx4 v[124:127], v1, s[20:23], s64 offen nt
  s_add_u32 s64, s7, 0x252000
  s_waitcnt vmcnt(15)
  buffer_load_dwordx4 v[128:131], v1, s[20:23], s64 offen nt
  s_add_u32 s64, s7, 0x255000
  s_waitcnt vmcnt(15)
  buffer_load_dwordx4 v[132:135], v1, s[20:23], s64 offen nt
  s_waitcnt vmcnt(32)
  v_lshlrev_b32 v136, 16, v6
  v_and_b32 v137, 0xffff0000, v6
  v_lshlrev_b32 v138, 16, v7
  v_and_b32 v139, 0xffff0000, v7
  s_mov_b32 s79, 0x3fb8aa3b
  v_mul_f32 v140, s79, -v136
  v_mul_f32 v141, s79, -v137
  v_mul_f32 v142, s79, -v138
  v_mul_f32 v143, s79, -v139
  v_min_f32 v140, 0x42f00000, v140
  v_min_f32 v141, 0x42f00000, v141
  v_min_f32 v142, 0x42f00000, v142
  v_min_f32 v143, 0x42f00000, v143
  v_exp_f32 v140, v140
  v_exp_f32 v141, v141
  v_exp_f32 v142, v142
  v_exp_f32 v143, v143
  v_add_f32 v140, 1.0, v140
  v_add_f32 v141, 1.0, v141
  v_add_f32 v142, 1.0, v142
  v_add_f32 v143, 1.0, v143
  v_rcp_f32 v144, v140
  v_rcp_f32 v145, v141
  v_rcp_f32 v146, v142
  v_rcp_f32 v147, v143
  v_mul_f32 v148, v136, v144
  v_fma_f32 v149, -v148, v140, v136
  v_fma_f32 v136, v149, v144, v148
  v_mul_f32 v148, v137, v145
  v_fma_f32 v149, -v148, v141, v137
  v_fma_f32 v137, v149, v145, v148
  v_mul_f32 v148, v138, v146
  v_fma_f32 v149, -v148, v142, v138
  v_fma_f32 v138, v149, v146, v148
  v_mul_f32 v148, v139, v147
  v_fma_f32 v149, -v148, v143, v139
  v_fma_f32 v139, v149, v147, v148
  v_cvt_pk_bf16_f32 v6, v136, v137
  v_cvt_pk_bf16_f32 v7, v138, v139
  s_lshl_b32 s64, s5, 9
  s_add_u32 s64, s64, 2304
  v_lshlrev_b32 v4, 3, v0
  v_add_u32 v4, s64, v4
  ds_write_b64 v4, v[6:7]
  v_lshrrev_b32 v1, 4, v0
  v_lshlrev_b32 v1, 5, v1
  v_and_b32 v4, 1, v0
  v_lshl_add_u32 v1, v4, 4, v1
  s_lshl_b32 s64, s5, 9
  s_add_u32 s64, s64, 2304
  v_add_u32 v1, s64, v1
  s_cbranch_execz L_vw_69
  s_waitcnt vmcnt(24)
L_vw_69:
  v_perm_b32 v136, v12, v8, s62
  v_perm_b32 v137, v20, v16, s62
  v_perm_b32 v138, v28, v24, s62
  v_perm_b32 v139, v36, v32, s62
  v_perm_b32 v140, v12, v8, s63
  v_perm_b32 v141, v20, v16, s63
  v_perm_b32 v142, v28, v24, s63
  v_perm_b32 v143, v36, v32, s63
  v_perm_b32 v144, v13, v9, s62
  v_perm_b32 v145, v21, v17, s62
  v_perm_b32 v146, v29, v25, s62
  v_perm_b32 v147, v37, v33, s62
  v_perm_b32 v148, v13, v9, s63
  v_perm_b32 v149, v21, v17, s63
  v_perm_b32 v150, v29, v25, s63
  v_perm_b32 v151, v37, v33, s63
  v_perm_b32 v152, v14, v10, s62
  v_perm_b32 v153, v22, v18, s62
  v_perm_b32 v154, v30, v26, s62
  v_perm_b32 v155, v38, v34, s62
  v_perm_b32 v156, v14, v10, s63
  v_perm_b32 v157, v22, v18, s63
  v_perm_b32 v158, v30, v26, s63
  v_perm_b32 v159, v38, v34, s63
  v_perm_b32 v160, v15, v11, s62
  v_perm_b32 v161, v23, v19, s62
  v_perm_b32 v162, v31, v27, s62
  v_perm_b32 v163, v39, v35, s62
  v_perm_b32 v164, v15, v11, s63
  v_perm_b32 v165, v23, v19, s63
  v_perm_b32 v166, v31, v27, s63
  v_perm_b32 v167, v39, v35, s63
  s_cbranch_execz L_vw_70
  s_waitcnt vmcnt(16)
L_vw_70:
  v_perm_b32 v8, v44, v40, s62
  v_perm_b32 v9, v52, v48, s62
  v_perm_b32 v10, v60, v56, s62
  v_perm_b32 v11, v68, v64, s62
  v_perm_b32 v12, v44, v40, s63
  v_perm_b32 v13, v52, v48, s63
  v_perm_b32 v14, v60, v56, s63
  v_perm_b32 v15, v68, v64, s63
  v_perm_b32 v16, v45, v41, s62
  v_perm_b32 v17, v53, v49, s62
  v_perm_b32 v18, v61, v57, s62
  v_perm_b32 v19, v69, v65, s62
  v_perm_b32 v20, v45, v41, s63
  v_perm_b32 v21, v53, v49, s63
  v_perm_b32 v22, v61, v57, s63
  v_perm_b32 v23, v69, v65, s63
  v_perm_b32 v24, v46, v42, s62
  v_perm_b32 v25, v54, v50, s62
  v_perm_b32 v26, v62, v58, s62
  v_perm_b32 v27, v70, v66, s62
  v_perm_b32 v28, v46, v42, s63
  v_perm_b32 v29, v54, v50, s63
  v_perm_b32 v30, v62, v58, s63
  v_perm_b32 v31, v70, v66, s63
  v_perm_b32 v32, v47, v43, s62
  v_perm_b32 v33, v55, v51, s62
  v_perm_b32 v34, v63, v59, s62
  v_perm_b32 v35, v71, v67, s62
  v_perm_b32 v36, v47, v43, s63
  v_perm_b32 v37, v55, v51, s63
  v_perm_b32 v38, v63, v59, s63
  v_perm_b32 v39, v71, v67, s63
  s_cbranch_execz L_vw_71
  s_waitcnt vmcnt(8)
L_vw_71:
  v_perm_b32 v40, v76, v72, s62
  v_perm_b32 v41, v84, v80, s62
  v_perm_b32 v42, v92, v88, s62
  v_perm_b32 v43, v100, v96, s62
  v_perm_b32 v44, v76, v72, s63
  v_perm_b32 v45, v84, v80, s63
  v_perm_b32 v46, v92, v88, s63
  v_perm_b32 v47, v100, v96, s63
  v_perm_b32 v48, v77, v73, s62
  v_perm_b32 v49, v85, v81, s62
  v_perm_b32 v50, v93, v89, s62
  v_perm_b32 v51, v101, v97, s62
  v_perm_b32 v52, v77, v73, s63
  v_perm_b32 v53, v85, v81, s63
  v_perm_b32 v54, v93, v89, s63
  v_perm_b32 v55, v101, v97, s63
  v_perm_b32 v56, v78, v74, s62
  v_perm_b32 v57, v86, v82, s62
  v_perm_b32 v58, v94, v90, s62
  v_perm_b32 v59, v102, v98, s62
  v_perm_b32 v60, v78, v74, s63
  v_perm_b32 v61, v86, v82, s63
  v_perm_b32 v62, v94, v90, s63
  v_perm_b32 v63, v102, v98, s63
  v_perm_b32 v64, v79, v75, s62
  v_perm_b32 v65, v87, v83, s62
  v_perm_b32 v66, v95, v91, s62
  v_perm_b32 v67, v103, v99, s62
  v_perm_b32 v68, v79, v75, s63
  v_perm_b32 v69, v87, v83, s63
  v_perm_b32 v70, v95, v91, s63
  v_perm_b32 v71, v103, v99, s63
  s_cbranch_execz L_vw_72
  s_waitcnt vmcnt(0)
L_vw_72:
  v_perm_b32 v72, v108, v104, s62
  v_perm_b32 v73, v116, v112, s62
  v_perm_b32 v74, v124, v120, s62
  v_perm_b32 v75, v132, v128, s62
  v_perm_b32 v76, v108, v104, s63
  v_perm_b32 v77, v116, v112, s63
  v_perm_b32 v78, v124, v120, s63
  v_perm_b32 v79, v132, v128, s63
  v_perm_b32 v80, v109, v105, s62
  v_perm_b32 v81, v117, v113, s62
  v_perm_b32 v82, v125, v121, s62
  v_perm_b32 v83, v133, v129, s62
  v_perm_b32 v84, v109, v105, s63
  v_perm_b32 v85, v117, v113, s63
  v_perm_b32 v86, v125, v121, s63
  v_perm_b32 v87, v133, v129, s63
  v_perm_b32 v88, v110, v106, s62
  v_perm_b32 v89, v118, v114, s62
  v_perm_b32 v90, v126, v122, s62
  v_perm_b32 v91, v134, v130, s62
  v_perm_b32 v92, v110, v106, s63
  v_perm_b32 v93, v118, v114, s63
  v_perm_b32 v94, v126, v122, s63
  v_perm_b32 v95, v134, v130, s63
  v_perm_b32 v96, v111, v107, s62
  v_perm_b32 v97, v119, v115, s62
  v_perm_b32 v98, v127, v123, s62
  v_perm_b32 v99, v135, v131, s62
  v_perm_b32 v100, v111, v107, s63
  v_perm_b32 v101, v119, v115, s63
  v_perm_b32 v102, v127, v123, s63
  v_perm_b32 v103, v135, v131, s63
  ds_read_b128 v[120:123], v1 offset:0
  ds_read_b128 v[124:127], v1 offset:128
  ds_read_b128 v[128:131], v1 offset:256
  ds_read_b128 v[132:135], v1 offset:384
  s_cbranch_execz L_ms_73
  s_waitcnt lgkmcnt(3)
  v_mfma_f32_16x16x32_bf16 v[104:107], v[120:123], v[136:139], 0
  v_mfma_f32_16x16x32_bf16 v[108:111], v[120:123], v[140:143], 0
  v_mfma_f32_16x16x32_bf16 v[112:115], v[120:123], v[144:147], 0
  v_mfma_f32_16x16x32_bf16 v[116:119], v[120:123], v[148:151], 0
  s_waitcnt lgkmcnt(2)
  v_mfma_f32_16x16x32_bf16 v[104:107], v[124:127], v[8:11], v[104:107]
  v_mfma_f32_16x16x32_bf16 v[108:111], v[124:127], v[12:15], v[108:111]
  v_mfma_f32_16x16x32_bf16 v[112:115], v[124:127], v[16:19], v[112:115]
  v_mfma_f32_16x16x32_bf16 v[116:119], v[124:127], v[20:23], v[116:119]
  s_waitcnt lgkmcnt(1)
  v_mfma_f32_16x16x32_bf16 v[104:107], v[128:131], v[40:43], v[104:107]
  v_mfma_f32_16x16x32_bf16 v[108:111], v[128:131], v[44:47], v[108:111]
  v_mfma_f32_16x16x32_bf16 v[112:115], v[128:131], v[48:51], v[112:115]
  v_mfma_f32_16x16x32_bf16 v[116:119], v[128:131], v[52:55], v[116:119]
  s_waitcnt lgkmcnt(0)
  v_mfma_f32_16x16x32_bf16 v[104:107], v[132:135], v[72:75], v[104:107]
  v_mfma_f32_16x16x32_bf16 v[108:111], v[132:135], v[76:79], v[108:111]
  v_mfma_f32_16x16x32_bf16 v[112:115], v[132:135], v[80:83], v[112:115]
  v_mfma_f32_16x16x32_bf16 v[116:119], v[132:135], v[84:87], v[116:119]
  v_mfma_f32_16x16x32_bf16 v[136:139], v[120:123], v[152:155], 0
  v_mfma_f32_16x16x32_bf16 v[140:143], v[120:123], v[156:159], 0
  v_mfma_f32_16x16x32_bf16 v[144:147], v[120:123], v[160:163], 0
  v_mfma_f32_16x16x32_bf16 v[148:151], v[120:123], v[164:167], 0
  v_mfma_f32_16x16x32_bf16 v[136:139], v[124:127], v[24:27], v[136:139]
  v_mfma_f32_16x16x32_bf16 v[140:143], v[124:127], v[28:31], v[140:143]
  v_mfma_f32_16x16x32_bf16 v[144:147], v[124:127], v[32:35], v[144:147]
  v_mfma_f32_16x16x32_bf16 v[148:151], v[124:127], v[36:39], v[148:151]
  v_mfma_f32_16x16x32_bf16 v[136:139], v[128:131], v[56:59], v[136:139]
  v_mfma_f32_16x16x32_bf16 v[140:143], v[128:131], v[60:63], v[140:143]
  v_mfma_f32_16x16x32_bf16 v[144:147], v[128:131], v[64:67], v[144:147]
  v_mfma_f32_16x16x32_bf16 v[148:151], v[128:131], v[68:71], v[148:151]
  v_mfma_f32_16x16x32_bf16 v[136:139], v[132:135], v[88:91], v[136:139]
  v_mfma_f32_16x16x32_bf16 v[140:143], v[132:135], v[92:95], v[140:143]
  v_mfma_f32_16x16x32_bf16 v[144:147], v[132:135], v[96:99], v[144:147]
  v_mfma_f32_16x16x32_bf16 v[148:151], v[132:135], v[100:103], v[148:151]
L_ms_73:
  v_add_f32_dpp v120, v105, v104 row_ror:8 row_mask:0xf bank_mask:0xf
  v_add_f32_dpp v121, v109, v108 row_ror:8 row_mask:0xf bank_mask:0xf
  v_add_f32_dpp v122, v113, v112 row_ror:8 row_mask:0xf bank_mask:0xf
  v_add_f32_dpp v123, v117, v116 row_ror:8 row_mask:0xf bank_mask:0xf
  s_nop 0
  v_add_f32_dpp v124, v137, v136 row_ror:8 row_mask:0xf bank_mask:0xf
  v_add_f32_dpp v125, v141, v140 row_ror:8 row_mask:0xf bank_mask:0xf
  v_add_f32_dpp v126, v145, v144 row_ror:8 row_mask:0xf bank_mask:0xf
  v_add_f32_dpp v127, v149, v148 row_ror:8 row_mask:0xf bank_mask:0xf
  s_lshl_b32 s64, s5, 8
  v_lshlrev_b32 v5, 5, v0
  v_add_u32 v5, s64, v5
  s_and_b64 exec, s[26:27], 0xff
  ds_write_b128 v5, v[120:123] offset:4352
  ds_write_b128 v5, v[124:127] offset:4368
  s_mov_b64 exec, s[26:27]
  v_mov_b32 v4, 1
  s_waitcnt lgkmcnt(0)
  s_and_b64 exec, s[26:27], 0x1
  ds_add_u32 v3, v4 offset:8
  s_mov_b64 exec, s[26:27]
  s_mov_b32 s68, 0
L_w_74:
  s_add_u32 s68, s68, 1
  s_cmp_gt_u32 s68, 0x400000
  s_cbranch_scc1 L_fail
  ds_read_b32 v4, v3 offset:8
  s_waitcnt lgkmcnt(0)
  v_readfirstlane_b32 s67, v4
  s_nop 0
  s_cmp_ge_u32 s67, 4
  s_cbranch_execz L_wd_75
  s_cbranch_scc0 L_w_74
L_wd_75:
  v_and_b32 v5, 15, v0
  v_lshlrev_b32 v5, 4, v5
  ds_read_b128 v[16:19], v5 offset:4352
  ds_read_b128 v[20:23], v5 offset:4608
  ds_read_b128 v[24:27], v5 offset:4864
  ds_read_b128 v[28:31], v5 offset:5120
  s_waitcnt lgkmcnt(2)
  v_add_f32 v8, v16, v20
  v_add_f32 v9, v17, v21
  v_add_f32 v10, v18, v22
  v_add_f32 v11, v19, v23
  s_waitcnt lgkmcnt(1)
  v_add_f32 v8, v8, v24
  v_add_f32 v9, v9, v25
  v_add_f32 v10, v10, v26
  v_add_f32 v11, v11, v27
  s_waitcnt lgkmcnt(0)
  v_add_f32 v8, v8, v28
  v_add_f32 v9, v9, v29
  v_add_f32 v10, v10, v30
  v_add_f32 v11, v11, v31
  v_cvt_pk_bf16_f32 v12, v8, v9
  v_cvt_pk_bf16_f32 v14, v10, v11
  v_mov_b32 v13, s4
  v_mov_b32 v15, s4
  v_and_b32 v5, 15, v0
  v_lshlrev_b32 v5, 4, v5
  v_lshrrev_b32 v6, 4, v0
  s_lshl_b32 s64, s5, 4
  v_add_u32 v6, s64, v6
  s_cmp_lt_u32 s6, 48
  s_cbranch_scc1 L_pub_g
  s_cmp_ge_u32 s6, 80
  s_cbranch_scc1 L_pub_g
  s_sub_u32 s64, s6, 48
  s_lshl_b32 s64, s64, 8
  s_add_u32 s64, s64, 0x200000
  v_add_u32 v7, 0, v6
  v_min_u32 v7, 55, v7
  v_lshl_add_u32 v7, v7, 13, v5
  s_cbranch_execz L_st_76
  buffer_store_dwordx4 v[12:15], v7, s[16:19], s64 offen offset:0 sc1
L_st_76:
  v_add_u32 v7, 4, v6
  v_min_u32 v7, 55, v7
  v_lshl_add_u32 v7, v7, 13, v5
  s_cbranch_execz L_st_77
  buffer_store_dwordx4 v[12:15], v7, s[16:19], s64 offen offset:0 sc1
L_st_77:
  v_add_u32 v7, 8, v6
  v_min_u32 v7, 55, v7
  v_lshl_add_u32 v7, v7, 13, v5
  s_cbranch_execz L_st_78
  buffer_store_dwordx4 v[12:15], v7, s[16:19], s64 offen offset:0 sc1
L_st_78:
  v_add_u32 v7, 12, v6
  v_min_u32 v7, 55, v7
  v_lshl_add_u32 v7, v7, 13, v5
  s_cbranch_execz L_st_79
  buffer_store_dwordx4 v[12:15], v7, s[16:19], s64 offen offset:0 sc1
L_st_79:
  s_branch L_pub_done
L_pub_g:
  s_cmp_lg_u32 s5, 0
  s_cbranch_scc1 L_pub_done
  s_and_b32 s64, s6, 15
  s_lshl_b32 s64, s64, 9
  s_cmp_ge_u32 s6, 80
  s_cselect_b32 s65, 128, 0
  s_add_u32 s64, s64, s65
  s_add_u32 s64, s64, 0x280000
  v_bfe_u32 v7, v0, 3, 1
  v_lshlrev_b32 v7, 8, v7
  v_and_b32 v6, 7, v0
  v_lshl_add_u32 v7, v6, 4, v7
  s_and_b64 exec, s[26:27], 0xffff
  s_cbranch_execz L_st_80
  buffer_store_dwordx4 v[12:15], v7, s[16:19], s64 offen offset:0 sc1
L_st_80:
  s_mov_b64 exec, s[26:27]
L_pub_done:
  s_cmp_lt_u32 s24, 8
  s_cbranch_scc1 L_s2
  s_branch L_warm_stream
L_p2:
  s_lshl_b32 s6, s25, 4
  s_add_u32 s6, s6, s24
  s_sub_u32 s6, s6, 32
  s_lshl_b32 s65, s6, 7
  s_mov_b32 s20, s38
  s_and_b32 s21, s39, 0xffff
  s_mov_b32 s22, 0x800000
  s_mov_b32 s23, 0x20000
  v_lshrrev_b32 v1, 3, v0
  v_mul_u32_u24 v1, 65536, v1
  v_and_b32 v4, 7, v0
  v_lshl_add_u32 v1, v4, 4, v1
  s_mul_i32 s7, s5, 2097152
  s_add_u32 s7, s7, s65
  s_add_u32 s64, s7, 0x0
  buffer_load_dwordx4 v[8:11], v1, s[20:23], s64 offen nt
  s_add_u32 s64, s7, 0x2000
  buffer_load_dwordx4 v[12:15], v1, s[20:23], s64 offen nt
  s_add_u32 s64, s7, 0x4000
  buffer_load_dwordx4 v[16:19], v1, s[20:23], s64 offen nt
  s_add_u32 s64, s7, 0x6000
  buffer_load_dwordx4 v[20:23], v1, s[20:23], s64 offen nt
  s_add_u32 s64, s7, 0x8000
  buffer_load_dwordx4 v[24:27], v1, s[20:23], s64 offen nt
  s_add_u32 s64, s7, 0xa000
  buffer_load_dwordx4 v[28:31], v1, s[20:23], s64 offen nt
  s_add_u32 s64, s7, 0xc000
  buffer_load_dwordx4 v[32:35], v1, s[20:23], s64 offen nt
  s_add_u32 s64, s7, 0xe000
  buffer_load_dwordx4 v[36:39], v1, s[20:23], s64 offen nt
  s_add_u32 s64, s7, 0x80000
  buffer_load_dwordx4 v[40:43], v1, s[20:23], s64 offen nt
  s_add_u32 s64, s7, 0x82000
  buffer_load_dwordx4 v[44:47], v1, s[20:23], s64 offen nt
  s_add_u32 s64, s7, 0x84000
  buffer_load_dwordx4 v[48:51], v1, s[20:23], s64 offen nt
  s_add_u32 s64, s7, 0x86000
  buffer_load_dwordx4 v[52:55], v1, s[20:23], s64 offen nt
  s_add_u32 s64, s7, 0x88000
  buffer_load_dwordx4 v[56:59], v1, s[20:23], s64 offen nt
  s_add_u32 s64, s7, 0x8a000
  buffer_load_dwordx4 v[60:63], v1, s[20:23], s64 offen nt
  s_add_u32 s64, s7, 0x8c000
  buffer_load_dwordx4 v[64:67], v1, s[20:23], s64 offen nt
  s_add_u32 s64, s7, 0x8e000
  buffer_load_dwordx4 v[68:71], v1, s[20:23], s64 offen nt
  s_add_u32 s64, s7, 0x100000
  buffer_load_dwordx4 v[72:75], v1, s[20:23], s64 offen nt
  s_add_u32 s64, s7, 0x102000
  buffer_load_dwordx4 v[76:79], v1, s[20:23], s64 offen nt
  s_add_u32 s64, s7, 0x104000
  buffer_load_dwordx4 v[80:83], v1, s[20:23], s64 offen nt
  s_add_u32 s64, s7, 0x106000
  buffer_load_dwordx4 v[84:87], v1, s[20:23], s64 offen nt
  s_add_u32 s64, s7, 0x108000
  buffer_load_dwordx4 v[88:91], v1, s[20:23], s64 offen nt
  s_add_u32 s64, s7, 0x10a000
  buffer_load_dwordx4 v[92:95], v1, s[20:23], s64 offen nt
  s_add_u32 s64, s7, 0x10c000
  buffer_load_dwordx4 v[96:99], v1, s[20:23], s64 offen nt
  s_add_u32 s64, s7, 0x10e000
  buffer_load_dwordx4 v[100:103], v1, s[20:23], s64 offen nt
  s_add_u32 s64, s7, 0x180000
  buffer_load_dwordx4 v[104:107], v1, s[20:23], s64 offen nt
  s_add_u32 s64, s7, 0x182000
  buffer_load_dwordx4 v[108:111], v1, s[20:23], s64 offen nt
  s_add_u32 s64, s7, 0x184000
  buffer_load_dwordx4 v[112:115], v1, s[20:23], s64 offen nt
  s_add_u32 s64, s7, 0x186000
  buffer_load_dwordx4 v[116:119], v1, s[20:23], s64 offen nt
  s_add_u32 s64, s7, 0x188000
  buffer_load_dwordx4 v[120:123], v1, s[20:23], s64 offen nt
  s_add_u32 s64, s7, 0x18a000
  buffer_load_dwordx4 v[124:127], v1, s[20:23], s64 offen nt
  s_add_u32 s64, s7, 0x18c000
  buffer_load_dwordx4 v[128:131], v1, s[20:23], s64 offen nt
  s_add_u32 s64, s7, 0x18e000
  buffer_load_dwordx4 v[132:135], v1, s[20:23], s64 offen nt
  s_waitcnt lgkmcnt(0)
  s_add_u32 s4, s4, 1
  v_lshrrev_b32 v1, 4, v0
  v_lshlrev_b32 v1, 5, v1
  v_and_b32 v4, 1, v0
  v_lshl_add_u32 v1, v4, 4, v1
  s_lshl_b32 s64, s5, 9
  s_add_u32 s64, s64, 2304
  v_add_u32 v1, s64, v1
  s_cbranch_execz L_vw_81
  s_waitcnt vmcnt(24)
L_vw_81:
  v_perm_b32 v136, v12, v8, s62
  v_perm_b32 v137, v20, v16, s62
  v_perm_b32 v138, v28, v24, s62
  v_perm_b32 v139, v36, v32, s62
  v_perm_b32 v140, v12, v8, s63
  v_perm_b32 v141, v20, v16, s63
  v_perm_b32 v142, v28, v24, s63
  v_perm_b32 v143, v36, v32, s63
  v_perm_b32 v144, v13, v9, s62
  v_perm_b32 v145, v21, v17, s62
  v_perm_b32 v146, v29, v25, s62
  v_perm_b32 v147, v37, v33, s62
  v_perm_b32 v148, v13, v9, s63
  v_perm_b32 v149, v21, v17, s63
  v_perm_b32 v150, v29, v25, s63
  v_perm_b32 v151, v37, v33, s63
  v_perm_b32 v152, v14, v10, s62
  v_perm_b32 v153, v22, v18, s62
  v_perm_b32 v154, v30, v26, s62
  v_perm_b32 v155, v38, v34, s62
  v_perm_b32 v156, v14, v10, s63
  v_perm_b32 v157, v22, v18, s63
  v_perm_b32 v158, v30, v26, s63
  v_perm_b32 v159, v38, v34, s63
  v_perm_b32 v160, v15, v11, s62
  v_perm_b32 v161, v23, v19, s62
  v_perm_b32 v162, v31, v27, s62
  v_perm_b32 v163, v39, v35, s62
  v_perm_b32 v164, v15, v11, s63
  v_perm_b32 v165, v23, v19, s63
  v_perm_b32 v166, v31, v27, s63
  v_perm_b32 v167, v39, v35, s63
  s_cbranch_execz L_vw_82
  s_waitcnt vmcnt(16)
L_vw_82:
  v_perm_b32 v8, v44, v40, s62
  v_perm_b32 v9, v52, v48, s62
  v_perm_b32 v10, v60, v56, s62
  v_perm_b32 v11, v68, v64, s62
  v_perm_b32 v12, v44, v40, s63
  v_perm_b32 v13, v52, v48, s63
  v_perm_b32 v14, v60, v56, s63
  v_perm_b32 v15, v68, v64, s63
  v_perm_b32 v16, v45, v41, s62
  v_perm_b32 v17, v53, v49, s62
  v_perm_b32 v18, v61, v57, s62
  v_perm_b32 v19, v69, v65, s62
  v_perm_b32 v20, v45, v41, s63
  v_perm_b32 v21, v53, v49, s63
  v_perm_b32 v22, v61, v57, s63
  v_perm_b32 v23, v69, v65, s63
  v_perm_b32 v24, v46, v42, s62
  v_perm_b32 v25, v54, v50, s62
  v_perm_b32 v26, v62, v58, s62
  v_perm_b32 v27, v70, v66, s62
  v_perm_b32 v28, v46, v42, s63
  v_perm_b32 v29, v54, v50, s63
  v_perm_b32 v30, v62, v58, s63
  v_perm_b32 v31, v70, v66, s63
  v_perm_b32 v32, v47, v43, s62
  v_perm_b32 v33, v55, v51, s62
  v_perm_b32 v34, v63, v59, s62
  v_perm_b32 v35, v71, v67, s62
  v_perm_b32 v36, v47, v43, s63
  v_perm_b32 v37, v55, v51, s63
  v_perm_b32 v38, v63, v59, s63
  v_perm_b32 v39, v71, v67, s63
  s_cbranch_execz L_vw_83
  s_waitcnt vmcnt(8)
L_vw_83:
  v_perm_b32 v40, v76, v72, s62
  v_perm_b32 v41, v84, v80, s62
  v_perm_b32 v42, v92, v88, s62
  v_perm_b32 v43, v100, v96, s62
  v_perm_b32 v44, v76, v72, s63
  v_perm_b32 v45, v84, v80, s63
  v_perm_b32 v46, v92, v88, s63
  v_perm_b32 v47, v100, v96, s63
  v_perm_b32 v48, v77, v73, s62
  v_perm_b32 v49, v85, v81, s62
  v_perm_b32 v50, v93, v89, s62
  v_perm_b32 v51, v101, v97, s62
  v_perm_b32 v52, v77, v73, s63
  v_perm_b32 v53, v85, v81, s63
  v_perm_b32 v54, v93, v89, s63
  v_perm_b32 v55, v101, v97, s63
  v_perm_b32 v56, v78, v74, s62
  v_perm_b32 v57, v86, v82, s62
  v_perm_b32 v58, v94, v90, s62
  v_perm_b32 v59, v102, v98, s62
  v_perm_b32 v60, v78, v74, s63
  v_perm_b32 v61, v86, v82, s63
  v_perm_b32 v62, v94, v90, s63
  v_perm_b32 v63, v102, v98, s63
  v_perm_b32 v64, v79, v75, s62
  v_perm_b32 v65, v87, v83, s62
  v_perm_b32 v66, v95, v91, s62
  v_perm_b32 v67, v103, v99, s62
  v_perm_b32 v68, v79, v75, s63
  v_perm_b32 v69, v87, v83, s63
  v_perm_b32 v70, v95, v91, s63
  v_perm_b32 v71, v103, v99, s63
  s_cbranch_execz L_vw_84
  s_waitcnt vmcnt(0)
L_vw_84:
  v_mov_b32 v4, 1
  s_waitcnt lgkmcnt(0)
  s_and_b64 exec, s[26:27], 0x1
  ds_add_u32 v3, v4 offset:28
  s_mov_b64 exec, s[26:27]
  v_perm_b32 v72, v108, v104, s62
  v_perm_b32 v73, v116, v112, s62
  v_perm_b32 v74, v124, v120, s62
  v_perm_b32 v75, v132, v128, s62
  v_perm_b32 v76, v108, v104, s63
  v_perm_b32 v77, v116, v112, s63
  v_perm_b32 v78, v124, v120, s63
  v_perm_b32 v79, v132, v128, s63
  v_perm_b32 v80, v109, v105, s62
  v_perm_b32 v81, v117, v113, s62
  v_perm_b32 v82, v125, v121, s62
  v_perm_b32 v83, v133, v129, s62
  v_perm_b32 v84, v109, v105, s63
  v_perm_b32 v85, v117, v113, s63
  v_perm_b32 v86, v125, v121, s63
  v_perm_b32 v87, v133, v129, s63
  v_perm_b32 v88, v110, v106, s62
  v_perm_b32 v89, v118, v114, s62
  v_perm_b32 v90, v126, v122, s62
  v_perm_b32 v91, v134, v130, s62
  v_perm_b32 v92, v110, v106, s63
  v_perm_b32 v93, v118, v114, s63
  v_perm_b32 v94, v126, v122, s63
  v_perm_b32 v95, v134, v130, s63
  v_perm_b32 v96, v111, v107, s62
  v_perm_b32 v97, v119, v115, s62
  v_perm_b32 v98, v127, v123, s62
  v_perm_b32 v99, v135, v131, s62
  v_perm_b32 v100, v111, v107, s63
  v_perm_b32 v101, v119, v115, s63
  v_perm_b32 v102, v127, v123, s63
  v_perm_b32 v103, v135, v131, s63
  s_lshl_b32 s80, s6, 12
  s_lshl_b32 s64, s5, 10
  s_add_u32 s80, s80, s64
  s_add_u32 s80, s80, 0x10000
  s_lshl_b32 s64, s5, 9
  s_add_u32 s64, s64, 2304
  v_lshlrev_b32 v5, 3, v0
  v_add_u32 v5, s64, v5
  s_mov_b32 s68, 0
L_p_85:
  s_add_u32 s68, s68, 1
  s_cmp_gt_u32 s68, 0x40000
  s_cbranch_scc1 L_fail
  s_cbranch_execz L_ps_86
  buffer_load_dwordx4 v[104:107], v2, s[16:19], s80 offen offset:0 sc1
  s_waitcnt vmcnt(0)
L_ps_86:
  s_mov_b64 s[70:71], -1
  v_cmp_eq_u32 vcc, s4, v105
  v_cmp_eq_u32 s[76:77], s4, v107
  s_and_b64 s[70:71], s[70:71], vcc
  s_and_b64 s[70:71], s[70:71], s[76:77]
  s_cmp_eq_u64 s[70:71], -1
  s_cbranch_execz L_pd_87
  s_cbranch_scc0 L_p_85
L_pd_87:
  v_mov_b32 v105, v106
  ds_write_b64 v5, v[104:105]
  ds_read_b128 v[120:123], v1 offset:0
  ds_read_b128 v[124:127], v1 offset:128
  ds_read_b128 v[128:131], v1 offset:256
  ds_read_b128 v[132:135], v1 offset:384
  s_cbranch_execz L_ms_88
  s_waitcnt lgkmcnt(3)
  v_mfma_f32_16x16x32_bf16 v[104:107], v[120:123], v[136:139], 0
  v_mfma_f32_16x16x32_bf16 v[108:111], v[120:123], v[140:143], 0
  v_mfma_f32_16x16x32_bf16 v[112:115], v[120:123], v[144:147], 0
  v_mfma_f32_16x16x32_bf16 v[116:119], v[120:123], v[148:151], 0
  s_waitcnt lgkmcnt(2)
  v_mfma_f32_16x16x32_bf16 v[104:107], v[124:127], v[8:11], v[104:107]
  v_mfma_f32_16x16x32_bf16 v[108:111], v[124:127], v[12:15], v[108:111]
  v_mfma_f32_16x16x32_bf16 v[112:115], v[124:127], v[16:19], v[112:115]
  v_mfma_f32_16x16x32_bf16 v[116:119], v[124:127], v[20:23], v[116:119]
  s_waitcnt lgkmcnt(1)
  v_mfma_f32_16x16x32_bf16 v[104:107], v[128:131], v[40:43], v[104:107]
  v_mfma_f32_16x16x32_bf16 v[108:111], v[128:131], v[44:47], v[108:111]
  v_mfma_f32_16x16x32_bf16 v[112:115], v[128:131], v[48:51], v[112:115]
  v_mfma_f32_16x16x32_bf16 v[116:119], v[128:131], v[52:55], v[116:119]
  s_waitcnt lgkmcnt(0)
  v_mfma_f32_16x16x32_bf16 v[104:107], v[132:135], v[72:75], v[104:107]
  v_mfma_f32_16x16x32_bf16 v[108:111], v[132:135], v[76:79], v[108:111]
  v_mfma_f32_16x16x32_bf16 v[112:115], v[132:135], v[80:83], v[112:115]
  v_mfma_f32_16x16x32_bf16 v[116:119], v[132:135], v[84:87], v[116:119]
  v_mfma_f32_16x16x32_bf16 v[136:139], v[120:123], v[152:155], 0
  v_mfma_f32_16x16x32_bf16 v[140:143], v[120:123], v[156:159], 0
  v_mfma_f32_16x16x32_bf16 v[144:147], v[120:123], v[160:163], 0
  v_mfma_f32_16x16x32_bf16 v[148:151], v[120:123], v[164:167], 0
  v_mfma_f32_16x16x32_bf16 v[136:139], v[124:127], v[24:27], v[136:139]
  v_mfma_f32_16x16x32_bf16 v[140:143], v[124:127], v[28:31], v[140:143]
  v_mfma_f32_16x16x32_bf16 v[144:147], v[124:127], v[32:35], v[144:147]
  v_mfma_f32_16x16x32_bf16 v[148:151], v[124:127], v[36:39], v[148:151]
  v_mfma_f32_16x16x32_bf16 v[136:139], v[128:131], v[56:59], v[136:139]
  v_mfma_f32_16x16x32_bf16 v[140:143], v[128:131], v[60:63], v[140:143]
  v_mfma_f32_16x16x32_bf16 v[144:147], v[128:131], v[64:67], v[144:147]
  v_mfma_f32_16x16x32_bf16 v[148:151], v[128:131], v[68:71], v[148:151]
  v_mfma_f32_16x16x32_bf16 v[136:139], v[132:135], v[88:91], v[136:139]
  v_mfma_f32_16x16x32_bf16 v[140:143], v[132:135], v[92:95], v[140:143]
  v_mfma_f32_16x16x32_bf16 v[144:147], v[132:135], v[96:99], v[144:147]
  v_mfma_f32_16x16x32_bf16 v[148:151], v[132:135], v[100:103], v[148:151]
L_ms_88:
  v_add_f32_dpp v120, v105, v104 row_ror:8 row_mask:0xf bank_mask:0xf
  v_add_f32_dpp v121, v109, v108 row_ror:8 row_mask:0xf bank_mask:0xf
  v_add_f32_dpp v122, v113, v112 row_ror:8 row_mask:0xf bank_mask:0xf
  v_add_f32_dpp v123, v117, v116 row_ror:8 row_mask:0xf bank_mask:0xf
  s_nop 0
  v_add_f32_dpp v124, v137, v136 row_ror:8 row_mask:0xf bank_mask:0xf
  v_add_f32_dpp v125, v141, v140 row_ror:8 row_mask:0xf bank_mask:0xf
  v_add_f32_dpp v126, v145, v144 row_ror:8 row_mask:0xf bank_mask:0xf
  v_add_f32_dpp v127, v149, v148 row_ror:8 row_mask:0xf bank_mask:0xf
  s_lshl_b32 s64, s5, 8
  v_lshlrev_b32 v5, 5, v0
  v_add_u32 v5, s64, v5
  s_and_b64 exec, s[26:27], 0xff
  ds_write_b128 v5, v[120:123] offset:4352
  ds_write_b128 v5, v[124:127] offset:4368
  s_mov_b64 exec, s[26:27]
  v_mov_b32 v4, 1
  s_waitcnt lgkmcnt(0)
  s_and_b64 exec, s[26:27], 0x1
  ds_add_u32 v3, v4 offset:8
  s_mov_b64 exec, s[26:27]
  s_mov_b32 s68, 0
L_w_89:
  s_add_u32 s68, s68, 1
  s_cmp_gt_u32 s68, 0x400000
  s_cbranch_scc1 L_fail
  ds_read_b32 v4, v3 offset:8
  s_waitcnt lgkmcnt(0)
  v_readfirstlane_b32 s67, v4
  s_nop 0
  s_cmp_ge_u32 s67, 4
  s_cbranch_execz L_wd_90
  s_cbranch_scc0 L_w_89
L_wd_90:
  v_and_b32 v5, 15, v0
  v_lshlrev_b32 v5, 4, v5
  ds_read_b128 v[16:19], v5 offset:4352
  ds_read_b128 v[20:23], v5 offset:4608
  ds_read_b128 v[24:27], v5 offset:4864
  ds_read_b128 v[28:31], v5 offset:5120
  s_waitcnt lgkmcnt(2)
  v_add_f32 v8, v16, v20
  v_add_f32 v9, v17, v21
  v_add_f32 v10, v18, v22
  v_add_f32 v11, v19, v23
  s_waitcnt lgkmcnt(1)
  v_add_f32 v8, v8, v24
  v_add_f32 v9, v9, v25
  v_add_f32 v10, v10, v26
  v_add_f32 v11, v11, v27
  s_waitcnt lgkmcnt(0)
  v_add_f32 v8, v8, v28
  v_add_f32 v9, v9, v29
  v_add_f32 v10, v10, v30
  v_add_f32 v11, v11, v31
  v_cvt_pk_bf16_f32 v12, v8, v9
  v_cvt_pk_bf16_f32 v14, v10, v11
  v_mov_b32 v13, s4
  v_mov_b32 v15, s4
  v_and_b32 v5, 15, v0
  v_lshlrev_b32 v5, 4, v5
  v_lshrrev_b32 v6, 4, v0
  v_lshl_add_u32 v7, v6, 12, v5
  s_lshr_b32 s64, s6, 4
  s_lshl_b32 s64, s64, 18
  s_lshl_b32 s65, s5, 16
  s_add_u32 s64, s64, s65
  s_and_b32 s65, s6, 15
  s_lshl_b32 s65, s65, 8
  s_add_u32 s64, s64, s65
  s_add_u32 s64, s64, 0x100000
  s_add_u32 s65, s64, 0x0
  s_cbranch_execz L_st_91
  buffer_store_dwordx4 v[12:15], v7, s[16:19], s65 offen offset:0 sc1
L_st_91:
  s_add_u32 s65, s64, 0x4000
  s_cbranch_execz L_st_92
  buffer_store_dwordx4 v[12:15], v7, s[16:19], s65 offen offset:0 sc1
L_st_92:
  s_add_u32 s65, s64, 0x8000
  s_cbranch_execz L_st_93
  buffer_store_dwordx4 v[12:15], v7, s[16:19], s65 offen offset:0 sc1
L_st_93:
  s_add_u32 s65, s64, 0xc000
  s_cbranch_execz L_st_94
  buffer_store_dwordx4 v[12:15], v7, s[16:19], s65 offen offset:0 sc1
L_st_94:
  s_cbranch_execz L_dryret
  s_branch L_warm_stream
L_s1:
  s_lshl_b32 s6, s25, 4
  s_add_u32 s6, s6, s24
  s_sub_u32 s6, s6, 48
  s_mov_b32 s68, 0
L_w_95:
  s_sleep 2
  s_add_u32 s68, s68, 1
  s_cmp_gt_u32 s68, 0x400000
  s_cbranch_scc1 L_fail
  ds_read_b32 v4, v3 offset:36
  s_waitcnt lgkmcnt(0)
  v_readfirstlane_b32 s67, v4
  s_nop 0
  s_cmp_ge_u32 s67, 8
  s_cbranch_execz L_wd_96
  s_cbranch_scc0 L_w_95
L_wd_96:
  s_mov_b32 s20, s40
  s_and_b32 s21, s41, 0xffff
  s_mov_b32 s22, 0x800000
  s_mov_b32 s23, 0x20000
  v_lshrrev_b32 v1, 5, v0
  v_lshlrev_b32 v1, 16, v1
  v_and_b32 v4, 31, v0
  v_lshl_add_u32 v1, v4, 4, v1
  s_lshl_b32 s7, s6, 17
  s_lshl_b32 s64, s5, 9
  s_add_u32 s7, s7, s64
  s_add_u32 s64, s7, 0x0
  buffer_load_dwordx4 v[8:11], v1, s[20:23], s64 offen nt
  s_add_u32 s64, s7, 0x4000
  buffer_load_dwordx4 v[12:15], v1, s[20:23], s64 offen nt
  s_add_u32 s64, s7, 0x800
  buffer_load_dwordx4 v[16:19], v1, s[20:23], s64 offen nt
  s_add_u32 s64, s7, 0x4800
  buffer_load_dwordx4 v[20:23], v1, s[20:23], s64 offen nt
  s_add_u32 s64, s7, 0x1000
  buffer_load_dwordx4 v[24:27], v1, s[20:23], s64 offen nt
  s_add_u32 s64, s7, 0x5000
  buffer_load_dwordx4 v[28:31], v1, s[20:23], s64 offen nt
  s_add_u32 s64, s7, 0x1800
  buffer_load_dwordx4 v[32:35], v1, s[20:23], s64 offen nt
  s_add_u32 s64, s7, 0x5800
  buffer_load_dwordx4 v[36:39], v1, s[20:23], s64 offen nt
  s_add_u32 s64, s7, 0x2000
  buffer_load_dwordx4 v[40:43], v1, s[20:23], s64 offen nt
  s_add_u32 s64, s7, 0x6000
  buffer_load_dwordx4 v[44:47], v1, s[20:23], s64 offen nt
  s_add_u32 s64, s7, 0x2800
  buffer_load_dwordx4 v[48:51], v1, s[20:23], s64 offen nt
  s_add_u32 s64, s7, 0x6800
  buffer_load_dwordx4 v[52:55], v1, s[20:23], s64 offen nt
  s_add_u32 s64, s7, 0x3000
  buffer_load_dwordx4 v[56:59], v1, s[20:23], s64 offen nt
  s_add_u32 s64, s7, 0x7000
  buffer_load_dwordx4 v[60:63], v1, s[20:23], s64 offen nt
  s_add_u32 s64, s7, 0x3800
  buffer_load_dwordx4 v[64:67], v1, s[20:23], s64 offen nt
  s_add_u32 s64, s7, 0x7800
  buffer_load_dwordx4 v[68:71], v1, s[20:23], s64 offen nt
  s_add_u32 s64, s7, 0x8000
  s_waitcnt vmcnt(15)
  buffer_load_dwordx4 v[72:75], v1, s[20:23], s64 offen nt
  s_add_u32 s64, s7, 0xc000
  s_waitcnt vmcnt(15)
  buffer_load_dwordx4 v[76:79], v1, s[20:23], s64 offen nt
  s_add_u32 s64, s7, 0x8800
  s_waitcnt vmcnt(15)
  buffer_load_dwordx4 v[80:83], v1, s[20:23], s64 offen nt
  s_add_u32 s64, s7, 0xc800
  s_waitcnt vmcnt(15)
  buffer_load_dwordx4 v[84:87], v1, s[20:23], s64 offen nt
  s_add_u32 s64, s7, 0x9000
  s_waitcnt vmcnt(15)
  buffer_load_dwordx4 v[88:91], v1, s[20:23], s64 offen nt
  s_add_u32 s64, s7, 0xd000
  s_waitcnt vmcnt(15)
  buffer_load_dwordx4 v[92:95], v1, s[20:23], s64 offen nt
  s_add_u32 s64, s7, 0x9800
  s_waitcnt vmcnt(15)
  buffer_load_dwordx4 v[96:99], v1, s[20:23], s64 offen nt
  s_add_u32 s64, s7, 0xd800
  s_waitcnt vmcnt(15)
  buffer_load_dwordx4 v[100:103], v1, s[20:23], s64 offen nt
  s_add_u32 s64, s7, 0xa000
  s_waitcnt vmcnt(15)
  buffer_load_dwordx4 v[104:107], v1, s[20:23], s64 offen nt
  s_add_u32 s64, s7, 0xe000
  s_waitcnt vmcnt(15)
  buffer_load_dwordx4 v[108:111], v1, s[20:23], s64 offen nt
  s_add_u32 s64, s7, 0xa800
  s_waitcnt vmcnt(15)
  buffer_load_dwordx4 v[112:115], v1, s[20:23], s64 offen nt
  s_add_u32 s64, s7, 0xe800
  s_waitcnt vmcnt(15)
  buffer_load_dwordx4 v[116:119], v1, s[20:23], s64 offen nt
  s_add_u32 s64, s7, 0xb000
  s_waitcnt vmcnt(15)
  buffer_load_dwordx4 v[120:123], v1, s[20:23], s64 offen nt
  s_add_u32 s64, s7, 0xf000
  s_waitcnt vmcnt(15)
  buffer_load_dwordx4 v[124:127], v1, s[20:23], s64 offen nt
  s_add_u32 s64, s7, 0xb800
  s_waitcnt vmcnt(15)
  buffer_load_dwordx4 v[128:131], v1, s[20:23], s64 offen nt
  s_add_u32 s64, s7, 0xf800
  s_waitcnt vmcnt(15)
  buffer_load_dwordx4 v[132:135], v1, s[20:23], s64 offen nt
  s_cbranch_execz L_vw_97
  s_waitcnt vmcnt(24)
L_vw_97:
  v_perm_b32 v136, v12, v8, s62
  v_perm_b32 v137, v20, v16, s62
  v_perm_b32 v138, v28, v24, s62
  v_perm_b32 v139, v36, v32, s62
  v_perm_b32 v140, v12, v8, s63
  v_perm_b32 v141, v20, v16, s63
  v_perm_b32 v142, v28, v24, s63
  v_perm_b32 v143, v36, v32, s63
  v_perm_b32 v144, v13, v9, s62
  v_perm_b32 v145, v21, v17, s62
  v_perm_b32 v146, v29, v25, s62
  v_perm_b32 v147, v37, v33, s62
  v_perm_b32 v148, v13, v9, s63
  v_perm_b32 v149, v21, v17, s63
  v_perm_b32 v150, v29, v25, s63
  v_perm_b32 v151, v37, v33, s63
  v_perm_b32 v152, v14, v10, s62
  v_perm_b32 v153, v22, v18, s62
  v_perm_b32 v154, v30, v26, s62
  v_perm_b32 v155, v38, v34, s62
  v_perm_b32 v156, v14, v10, s63
  v_perm_b32 v157, v22, v18, s63
  v_perm_b32 v158, v30, v26, s63
  v_perm_b32 v159, v38, v34, s63
  v_perm_b32 v160, v15, v11, s62
  v_perm_b32 v161, v23, v19, s62
  v_perm_b32 v162, v31, v27, s62
  v_perm_b32 v163, v39, v35, s62
  v_perm_b32 v164, v15, v11, s63
  v_perm_b32 v165, v23, v19, s63
  v_perm_b32 v166, v31, v27, s63
  v_perm_b32 v167, v39, v35, s63
  s_cbranch_execz L_vw_98
  s_waitcnt vmcnt(16)
L_vw_98:
  v_perm_b32 v8, v44, v40, s62
  v_perm_b32 v9, v52, v48, s62
  v_perm_b32 v10, v60, v56, s62
  v_perm_b32 v11, v68, v64, s62
  v_perm_b32 v12, v44, v40, s63
  v_perm_b32 v13, v52, v48, s63
  v_perm_b32 v14, v60, v56, s63
  v_perm_b32 v15, v68, v64, s63
  v_perm_b32 v16, v45, v41, s62
  v_perm_b32 v17, v53, v49, s62
  v_perm_b32 v18, v61, v57, s62
  v_perm_b32 v19, v69, v65, s62
  v_perm_b32 v20, v45, v41, s63
  v_perm_b32 v21, v53, v49, s63
  v_perm_b32 v22, v61, v57, s63
  v_perm_b32 v23, v69, v65, s63
  v_perm_b32 v24, v46, v42, s62
  v_perm_b32 v25, v54, v50, s62
  v_perm_b32 v26, v62, v58, s62
  v_perm_b32 v27, v70, v66, s62
  v_perm_b32 v28, v46, v42, s63
  v_perm_b32 v29, v54, v50, s63
  v_perm_b32 v30, v62, v58, s63
  v_perm_b32 v31, v70, v66, s63
  v_perm_b32 v32, v47, v43, s62
  v_perm_b32 v33, v55, v51, s62
  v_perm_b32 v34, v63, v59, s62
  v_perm_b32 v35, v71, v67, s62
  v_perm_b32 v36, v47, v43, s63
  v_perm_b32 v37, v55, v51, s63
  v_perm_b32 v38, v63, v59, s63
  v_perm_b32 v39, v71, v67, s63
  s_cbranch_execz L_vw_99
  s_waitcnt vmcnt(8)
L_vw_99:
  v_perm_b32 v40, v76, v72, s62
  v_perm_b32 v41, v84, v80, s62
  v_perm_b32 v42, v92, v88, s62
  v_perm_b32 v43, v100, v96, s62
  v_perm_b32 v44, v76, v72, s63
  v_perm_b32 v45, v84, v80, s63
  v_perm_b32 v46, v92, v88, s63
  v_perm_b32 v47, v100, v96, s63
  v_perm_b32 v48, v77, v73, s62
  v_perm_b32 v49, v85, v81, s62
  v_perm_b32 v50, v93, v89, s62
  v_perm_b32 v51, v101, v97, s62
  v_perm_b32 v52, v77, v73, s63
  v_perm_b32 v53, v85, v81, s63
  v_perm_b32 v54, v93, v89, s63
  v_perm_b32 v55, v101, v97, s63
  v_perm_b32 v56, v78, v74, s62
  v_perm_b32 v57, v86, v82, s62
  v_perm_b32 v58, v94, v90, s62
  v_perm_b32 v59, v102, v98, s62
  v_perm_b32 v60, v78, v74, s63
  v_perm_b32 v61, v86, v82, s63
  v_perm_b32 v62, v94, v90, s63
  v_perm_b32 v63, v102, v98, s63
  v_perm_b32 v64, v79, v75, s62
  v_perm_b32 v65, v87, v83, s62
  v_perm_b32 v66, v95, v91, s62
  v_perm_b32 v67, v103, v99, s62
  v_perm_b32 v68, v79, v75, s63
  v_perm_b32 v69, v87, v83, s63
  v_perm_b32 v70, v95, v91, s63
  v_perm_b32 v71, v103, v99, s63
  s_cbranch_execz L_vw_100
  s_waitcnt vmcnt(0)
L_vw_100:
  v_perm_b32 v72, v108, v104, s62
  v_perm_b32 v73, v116, v112, s62
  v_perm_b32 v74, v124, v120, s62
  v_perm_b32 v75, v132, v128, s62
  v_perm_b32 v76, v108, v104, s63
  v_perm_b32 v77, v116, v112, s63
  v_perm_b32 v78, v124, v120, s63
  v_perm_b32 v79, v132, v128, s63
  v_perm_b32 v80, v109, v105, s62
  v_perm_b32 v81, v117, v113, s62
  v_perm_b32 v82, v125, v121, s62
  v_perm_b32 v83, v133, v129, s62
  v_perm_b32 v84, v109, v105, s63
  v_perm_b32 v85, v117, v113, s63
  v_perm_b32 v86, v125, v121, s63
  v_perm_b32 v87, v133, v129, s63
  v_perm_b32 v88, v110, v106, s62
  v_perm_b32 v89, v118, v114, s62
  v_perm_b32 v90, v126, v122, s62
  v_perm_b32 v91, v134, v130, s62
  v_perm_b32 v92, v110, v106, s63
  v_perm_b32 v93, v118, v114, s63
  v_perm_b32 v94, v126, v122, s63
  v_perm_b32 v95, v134, v130, s63
  v_perm_b32 v96, v111, v107, s62
  v_perm_b32 v97, v119, v115, s62
  v_perm_b32 v98, v127, v123, s62
  v_perm_b32 v99, v135, v131, s62
  v_perm_b32 v100, v111, v107, s63
  v_perm_b32 v101, v119, v115, s63
  v_perm_b32 v102, v127, v123, s63
  v_perm_b32 v103, v135, v131, s63
  v_lshrrev_b32 v1, 5, v0
  v_lshlrev_b32 v1, 4, v1
  v_add_u32 v1, 5952, v1
  v_lshrrev_b32 v4, 4, v0
  v_xor_b32 v4, v4, v0
  v_and_b32 v4, 1, v4
  v_cmp_eq_u32 vcc, 0, v4
  v_mov_b32 v4, 64
  s_nop 0
  v_cndmask_b32 v1, v4, v1, vcc
  v_lshrrev_b32 v4, 4, v0
  v_cmp_eq_u32 s[72:73], 1, v4
  v_cmp_eq_u32 s[74:75], 2, v4
  v_cmp_eq_u32 s[82:83], 3, v4
  v_bfe_u32 v5, v0, 2, 2
  v_lshlrev_b32 v5, 14, v5
  v_and_b32 v6, 3, v0
  v_lshl_add_u32 v5, v6, 12, v5
  v_lshrrev_b32 v6, 4, v0
  v_lshl_add_u32 v5, v6, 4, v5
  s_lshl_b32 s80, s5, 17
  s_lshl_b32 s64, s6, 6
  s_add_u32 s80, s80, s64
  s_add_u32 s80, s80, 0x500000
  s_add_u32 s81, s80, 0x10000
  s_mov_b32 s68, 0
L_w_101:
  s_sleep 1
  s_add_u32 s68, s68, 1
  s_cmp_gt_u32 s68, 0x400000
  s_cbranch_scc1 L_fail
  ds_read_b32 v4, v3 offset:40
  s_waitcnt lgkmcnt(0)
  v_readfirstlane_b32 s67, v4
  s_nop 0
  s_cmp_ge_u32 s67, 8
  s_cbranch_execz L_wd_102
  s_cbranch_scc0 L_w_101
L_wd_102:
  s_mov_b32 s68, 0
L_ls_103:
  s_sleep 1
  ds_read_b128 v[120:123], v1 offset:0
  ds_read_b128 v[124:127], v1 offset:32
  ds_read_b128 v[128:131], v1 offset:64
  ds_read_b128 v[132:135], v1 offset:96
  s_add_u32 s68, s68, 1
  s_cmp_gt_u32 s68, 0x400000
  s_cbranch_scc1 L_fail
  s_waitcnt lgkmcnt(0)
  v_max3_u32 v4, v120, v124, v128
  v_max_u32 v4, v4, v132
  v_cmp_eq_u32 vcc, -1, v4
  s_nop 0
  s_cmp_eq_u64 vcc, 0
  s_cbranch_scc0 L_ls_103
  s_cbranch_execz L_ms_104
  s_waitcnt lgkmcnt(3)
  v_mfma_f32_16x16x32_bf16 v[104:107], v[120:123], v[136:139], 0
  v_mfma_f32_16x16x32_bf16 v[108:111], v[120:123], v[140:143], 0
  v_mfma_f32_16x16x32_bf16 v[112:115], v[120:123], v[144:147], 0
  v_mfma_f32_16x16x32_bf16 v[116:119], v[120:123], v[148:151], 0
  s_waitcnt lgkmcnt(2)
  v_mfma_f32_16x16x32_bf16 v[104:107], v[124:127], v[8:11], v[104:107]
  v_mfma_f32_16x16x32_bf16 v[108:111], v[124:127], v[12:15], v[108:111]
  v_mfma_f32_16x16x32_bf16 v[112:115], v[124:127], v[16:19], v[112:115]
  v_mfma_f32_16x16x32_bf16 v[116:119], v[124:127], v[20:23], v[116:119]
  s_waitcnt lgkmcnt(1)
  v_mfma_f32_16x16x32_bf16 v[104:107], v[128:131], v[40:43], v[104:107]
  v_mfma_f32_16x16x32_bf16 v[108:111], v[128:131], v[44:47], v[108:111]
  v_mfma_f32_16x16x32_bf16 v[112:115], v[128:131], v[48:51], v[112:115]
  v_mfma_f32_16x16x32_bf16 v[116:119], v[128:131], v[52:55], v[116:119]
  s_waitcnt lgkmcnt(0)
  v_mfma_f32_16x16x32_bf16 v[104:107], v[132:135], v[72:75], v[104:107]
  v_mfma_f32_16x16x32_bf16 v[108:111], v[132:135], v[76:79], v[108:111]
  v_mfma_f32_16x16x32_bf16 v[112:115], v[132:135], v[80:83], v[112:115]
  v_mfma_f32_16x16x32_bf16 v[116:119], v[132:135], v[84:87], v[116:119]
  v_mfma_f32_16x16x32_bf16 v[136:139], v[120:123], v[152:155], 0
  v_mfma_f32_16x16x32_bf16 v[140:143], v[120:123], v[156:159], 0
  v_mfma_f32_16x16x32_bf16 v[144:147], v[120:123], v[160:163], 0
  v_mfma_f32_16x16x32_bf16 v[148:151], v[120:123], v[164:167], 0
  v_mfma_f32_16x16x32_bf16 v[136:139], v[124:127], v[24:27], v[136:139]
  v_mfma_f32_16x16x32_bf16 v[140:143], v[124:127], v[28:31], v[140:143]
  v_mfma_f32_16x16x32_bf16 v[144:147], v[124:127], v[32:35], v[144:147]
  v_mfma_f32_16x16x32_bf16 v[148:151], v[124:127], v[36:39], v[148:151]
  v_mfma_f32_16x16x32_bf16 v[136:139], v[128:131], v[56:59], v[136:139]
  v_mfma_f32_16x16x32_bf16 v[140:143], v[128:131], v[60:63], v[140:143]
  v_mfma_f32_16x16x32_bf16 v[144:147], v[128:131], v[64:67], v[144:147]
  v_mfma_f32_16x16x32_bf16 v[148:151], v[128:131], v[68:71], v[148:151]
  v_mfma_f32_16x16x32_bf16 v[136:139], v[132:135], v[88:91], v[136:139]
  v_mfma_f32_16x16x32_bf16 v[140:143], v[132:135], v[92:95], v[140:143]
  v_mfma_f32_16x16x32_bf16 v[144:147], v[132:135], v[96:99], v[144:147]
  v_mfma_f32_16x16x32_bf16 v[148:151], v[132:135], v[100:103], v[148:151]
L_ms_104:
  v_cndmask_b32 v120, v104, v112, s[72:73]
  s_nop 3
  v_cndmask_b32 v120, v120, v136, s[74:75]
  s_nop 0
  v_cndmask_b32 v120, v120, v144, s[82:83]
  v_mov_b32 v121, s4
  v_cndmask_b32 v122, v108, v116, s[72:73]
  v_cndmask_b32 v122, v122, v140, s[74:75]
  v_cndmask_b32 v122, v122, v148, s[82:83]
  v_mov_b32 v123, s4
  v_cndmask_b32 v124, v105, v113, s[72:73]
  v_cndmask_b32 v124, v124, v137, s[74:75]
  v_cndmask_b32 v124, v124, v145, s[82:83]
  v_mov_b32 v125, s4
  v_cndmask_b32 v126, v109, v117, s[72:73]
  v_cndmask_b32 v126, v126, v141, s[74:75]
  v_cndmask_b32 v126, v126, v149, s[82:83]
  v_mov_b32 v127, s4
  s_cbranch_execz L_st_105
  buffer_store_dwordx4 v[120:123], v5, s[16:19], s80 offen offset:0 sc1
L_st_105:
  s_cbranch_execz L_st_106
  buffer_store_dwordx4 v[124:127], v5, s[16:19], s81 offen offset:0 sc1
L_st_106:
  s_cbranch_execz L_dryret
  s_branch L_end
L_s2:
  s_lshl_b32 s6, s25, 3
  s_add_u32 s6, s6, s24
  v_and_b32 v19, 3, v0
  v_lshlrev_b32 v19, 2, v19
  s_lshl_b32 s64, s5, 4
  v_add_u32 v19, s64, v19
  s_lshl_b32 s65, s6, 6
  v_add_u32 v20, s65, v19
  global_load_dword v6, v20, s[32:33]
  global_load_dword v7, v20, s[50:51]
  v_and_b32 v5, 15, v0
  v_lshlrev_b32 v4, 4, v5
  s_lshl_b32 s80, s6, 8
  s_add_u32 s80, s80, 0x280000
  s_mov_b32 s68, 0
L_p_107:
  s_add_u32 s68, s68, 1
  s_cmp_gt_u32 s68, 0x40000
  s_cbranch_scc1 L_fail
  s_cbranch_execz L_ps_108
  buffer_load_dwordx4 v[24:27], v4, s[16:19], s80 offen offset:0 sc1
  s_waitcnt vmcnt(0)
L_ps_108:
  s_mov_b64 s[70:71], -1
  v_cmp_eq_u32 vcc, s4, v25
  v_cmp_eq_u32 s[76:77], s4, v27
  s_and_b64 s[70:71], s[70:71], vcc
  s_and_b64 s[70:71], s[70:71], s[76:77]
  s_cmp_eq_u64 s[70:71], -1
  s_cbranch_execz L_pd_109
  s_cbranch_scc1 L_pd_109
  s_sleep 100
  s_branch L_p_107
L_pd_109:
  v_mov_b32 v25, v26
  v_lshlrev_b32 v5, 3, v5
  ds_write_b64 v5, v[24:25] offset:7424
  ds_read_b32 v28, v19 offset:7424
  ds_read_b32 v29, v19 offset:7488
  s_waitcnt lgkmcnt(0)
  v_lshlrev_b32 v8, 16, v6
  v_and_b32 v9, 0xffff0000, v6
  v_lshlrev_b32 v14, 16, v7
  v_and_b32 v15, 0xffff0000, v7
  v_lshlrev_b32 v10, 16, v28
  v_and_b32 v11, 0xffff0000, v28
  v_lshlrev_b32 v12, 16, v29
  v_and_b32 v13, 0xffff0000, v29
  v_lshrrev_b32 v5, 1, v0
  v_and_b32 v4, 1, v0
  v_lshlrev_b32 v4, 4, v4
  v_add_u32 v17, 32, v5
  v_min_u32 v17, 55, v17
  v_lshl_add_u32 v16, v5, 12, v4
  v_lshl_add_u32 v17, v17, 12, v4
  v_add_u32 v18, 192, v0
  v_min_u32 v18, 223, v18
  v_lshlrev_b32 v18, 4, v18
L_s2_seg:
  s_lshl_b32 s80, s6, 14
  s_lshl_b32 s64, s5, 12
  s_add_u32 s80, s80, s64
  s_add_u32 s80, s80, 0x500000
  s_lshl_b32 s81, s6, 7
  s_lshl_b32 s64, s5, 5
  s_add_u32 s81, s81, s64
  s_add_u32 s81, s81, 0x580000
  s_mul_i32 s78, s6, 14336
  s_mul_i32 s64, s5, 3584
  s_add_u32 s78, s78, s64
  s_add_u32 s78, s78, 0x600000
  s_mov_b32 s68, 0
L_w_110:
  s_sleep 1
  s_add_u32 s68, s68, 1
  s_cmp_gt_u32 s68, 0x400000
  s_cbranch_scc1 L_fail
  ds_read_b32 v4, v3 offset:40
  s_waitcnt lgkmcnt(0)
  v_readfirstlane_b32 s67, v4
  s_nop 0
  s_cmp_ge_u32 s67, 8
  s_cbranch_execz L_wd_111
  s_cbranch_scc0 L_w_110
L_wd_111:
  v_mov_b32 v41, s4
  v_mov_b32 v43, s4
  s_mov_b32 s68, 0
L_pp_112:
  buffer_load_dwordx4 v[24:27], v2, s[16:19], s80 offen offset:0 sc1
  buffer_load_dwordx4 v[28:31], v2, s[16:19], s80 offen offset:1024 sc1
  buffer_load_dwordx4 v[32:35], v2, s[16:19], s80 offen offset:2048 sc1
  buffer_load_dwordx4 v[36:39], v2, s[16:19], s80 offen offset:3072 sc1
  s_add_u32 s68, s68, 1
  s_cmp_gt_u32 s68, 0x80000
  s_cbranch_scc1 L_fail
  s_mov_b64 s[70:71], -1
  s_waitcnt vmcnt(0)
  v_cmp_eq_u32 vcc, s4, v25
  v_cmp_eq_u32 s[76:77], s4, v27
  s_and_b64 s[70:71], s[70:71], vcc
  s_and_b64 s[70:71], s[70:71], s[76:77]
  v_cmp_eq_u32 vcc, s4, v29
  v_cmp_eq_u32 s[76:77], s4, v31
  s_and_b64 s[70:71], s[70:71], vcc
  s_and_b64 s[70:71], s[70:71], s[76:77]
  v_cmp_eq_u32 vcc, s4, v33
  v_cmp_eq_u32 s[76:77], s4, v35
  s_and_b64 s[70:71], s[70:71], vcc
  s_and_b64 s[70:71], s[70:71], s[76:77]
  v_cmp_eq_u32 vcc, s4, v37
  v_cmp_eq_u32 s[76:77], s4, v39
  s_and_b64 s[70:71], s[70:71], vcc
  s_and_b64 s[70:71], s[70:71], s[76:77]
  s_cmp_eq_u64 s[70:71], -1
  s_cbranch_scc0 L_pp_112
  v_add_f32 v44, v24, v28
  v_add_f32 v45, v26, v30
  v_add_f32 v44, v44, v32
  v_add_f32 v45, v45, v34
  v_add_f32 v44, v44, v36
  v_add_f32 v45, v45, v38
  s_nop 0
  v_add_f32_dpp v44, v44, v44 row_ror:4 row_mask:0xf bank_mask:0xf
  v_add_f32_dpp v45, v45, v45 row_ror:4 row_mask:0xf bank_mask:0xf
  s_nop 0
  v_add_f32_dpp v44, v44, v44 row_ror:8 row_mask:0xf bank_mask:0xf
  v_add_f32_dpp v45, v45, v45 row_ror:8 row_mask:0xf bank_mask:0xf
  v_mov_b32 v46, v44
  v_mov_b32 v47, v45
  s_nop 0
  v_permlane16_swap_b32 v44, v46
  v_permlane16_swap_b32 v45, v47
  v_add_f32 v44, v44, v46
  v_add_f32 v45, v45, v47
  v_mov_b32 v46, v44
  v_mov_b32 v47, v45
  s_nop 0
  v_permlane32_swap_b32 v44, v46
  v_permlane32_swap_b32 v45, v47
  v_add_f32 v44, v44, v46
  v_add_f32 v45, v45, v47
  v_cvt_pk_bf16_f32 v46, v44, v45
  v_lshlrev_b32 v44, 16, v46
  v_and_b32 v45, 0xffff0000, v46
  v_mul_f32 v44, v44, v10
  v_mul_f32 v45, v45, v11
  v_cvt_pk_bf16_f32 v46, v44, v45
  v_lshlrev_b32 v44, 16, v46
  v_and_b32 v45, 0xffff0000, v46
  v_add_f32 v44, v44, v8
  v_add_f32 v45, v45, v9
  v_cvt_pk_bf16_f32 v46, v44, v45
  s_nop 1
  v_mov_b32_dpp v40, v46 quad_perm:[0,2,0,2] row_mask:0xf bank_mask:0xf
  v_mov_b32_dpp v42, v46 quad_perm:[1,3,1,3] row_mask:0xf bank_mask:0xf
  s_cbranch_execz L_st_113
  buffer_store_dwordx4 v[40:43], v16, s[16:19], s81 offen offset:0 sc1
L_st_113:
  s_cbranch_execz L_st_114
  buffer_store_dwordx4 v[40:43], v17, s[16:19], s81 offen offset:0 sc1
L_st_114:
  v_lshlrev_b32 v8, 16, v46
  v_and_b32 v9, 0xffff0000, v46
  s_waitcnt vmcnt(0)
  s_mov_b32 s68, 0
L_pp_115:
  buffer_load_dwordx4 v[24:27], v2, s[16:19], s78 offen offset:0 sc1
  buffer_load_dwordx4 v[28:31], v2, s[16:19], s78 offen offset:1024 sc1
  buffer_load_dwordx4 v[32:35], v2, s[16:19], s78 offen offset:2048 sc1
  buffer_load_dwordx4 v[36:39], v18, s[16:19], s78 offen offset:0 sc1
  s_add_u32 s68, s68, 1
  s_cmp_gt_u32 s68, 0x80000
  s_cbranch_scc1 L_fail
  s_mov_b64 s[70:71], -1
  s_waitcnt vmcnt(0)
  v_cmp_eq_u32 vcc, s4, v25
  v_cmp_eq_u32 s[76:77], s4, v27
  s_and_b64 s[70:71], s[70:71], vcc
  s_and_b64 s[70:71], s[70:71], s[76:77]
  v_cmp_eq_u32 vcc, s4, v29
  v_cmp_eq_u32 s[76:77], s4, v31
  s_and_b64 s[70:71], s[70:71], vcc
  s_and_b64 s[70:71], s[70:71], s[76:77]
  v_cmp_eq_u32 vcc, s4, v33
  v_cmp_eq_u32 s[76:77], s4, v35
  s_and_b64 s[70:71], s[70:71], vcc
  s_and_b64 s[70:71], s[70:71], s[76:77]
  v_cmp_eq_u32 vcc, s4, v37
  v_cmp_eq_u32 s[76:77], s4, v39
  s_and_b64 s[70:71], s[70:71], vcc
  s_and_b64 s[70:71], s[70:71], s[76:77]
  s_cmp_eq_u64 s[70:71], -1
  s_cbranch_scc0 L_pp_115
  v_add_f32 v44, v24, v28
  v_add_f32 v45, v26, v30
  v_add_f32 v44, v44, v32
  v_add_f32 v45, v45, v34
  s_mov_b32 exec_lo, s26
  s_mov_b32 exec_hi, 0
  v_add_f32 v44, v44, v36
  v_add_f32 v45, v45, v38
  s_mov_b64 exec, s[26:27]
  v_add_f32_dpp v44, v44, v44 row_ror:4 row_mask:0xf bank_mask:0xf
  v_add_f32_dpp v45, v45, v45 row_ror:4 row_mask:0xf bank_mask:0xf
  s_nop 0
  v_add_f32_dpp v44, v44, v44 row_ror:8 row_mask:0xf bank_mask:0xf
  v_add_f32_dpp v45, v45, v45 row_ror:8 row_mask:0xf bank_mask:0xf
  v_mov_b32 v46, v44
  v_mov_b32 v47, v45
  s_nop 0
  v_permlane16_swap_b32 v44, v46
  v_permlane16_swap_b32 v45, v47
  v_add_f32 v44, v44, v46
  v_add_f32 v45, v45, v47
  v_mov_b32 v46, v44
  v_mov_b32 v47, v45
  s_nop 0
  v_permlane32_swap_b32 v44, v46
  v_permlane32_swap_b32 v45, v47
  v_add_f32 v44, v44, v46
  v_add_f32 v45, v45, v47
  v_cvt_pk_bf16_f32 v46, v44, v45
  v_lshlrev_b32 v44, 16, v46
  v_and_b32 v45, 0xffff0000, v46
  v_add_f32 v44, v44, v14
  v_add_f32 v45, v45, v15
  v_cvt_pk_bf16_f32 v46, v44, v45
  v_lshlrev_b32 v44, 16, v46
  v_and_b32 v45, 0xffff0000, v46
  v_mul_f32 v44, v44, v12
  v_mul_f32 v45, v45, v13
  v_cvt_pk_bf16_f32 v46, v44, v45
  v_lshlrev_b32 v44, 16, v46
  v_and_b32 v45, 0xffff0000, v46
  v_add_f32 v44, v44, v8
  v_add_f32 v45, v45, v9
  v_cvt_pk_bf16_f32 v46, v44, v45
  s_and_b64 exec, s[26:27], 0xf
  buffer_store_dword v46, v20, s[28:31], 0 offen
  s_mov_b64 exec, s[26:27]
  s_cmp_lg_u32 s2, 0
  s_cbranch_scc1 L_end
  s_cmp_lg_u32 s5, 0
  s_cbranch_scc1 L_end
  v_mov_b32 v4, s4
  s_and_b64 exec, s[26:27], 0x1
  buffer_store_dword v4, v3, s[16:19], 0 offen sc1
  s_mov_b64 exec, s[26:27]
  s_branch L_end
L_s3:
  s_mul_i32 s6, s25, 14
  s_add_u32 s6, s6, s24
  s_sub_u32 s6, s6, 8
  s_lshl_b32 s65, s6, 7
  v_and_b32 v5, 15, v0
  v_lshlrev_b32 v5, 3, v5
  v_add_u32 v4, s65, v5
  global_load_dwordx2 v[6:7], v4, s[46:47]
  s_waitcnt vmcnt(0)
  ds_write_b64 v5, v[6:7] offset:7552
  v_mov_b32 v4, 1
  s_waitcnt lgkmcnt(0)
  s_and_b64 exec, s[26:27], 0x1
  ds_add_u32 v3, v4 offset:32
  s_mov_b64 exec, s[26:27]
  s_lshl_b32 s65, s6, 7
  s_mov_b32 s20, s44
  s_and_b32 s21, s45, 0xffff
  s_mov_b32 s22, 0x700000
  s_mov_b32 s23, 0x20000
  v_lshrrev_b32 v1, 3, v0
  v_mul_u32_u24 v1, 57344, v1
  v_and_b32 v4, 7, v0
  v_lshl_add_u32 v1, v4, 4, v1
  s_mul_i32 s7, s5, 1835008
  s_add_u32 s7, s7, s65
  s_add_u32 s64, s7, 0x0
  buffer_load_dwordx4 v[8:11], v1, s[20:23], s64 offen nt
  s_add_u32 s64, s7, 0x1c00
  buffer_load_dwordx4 v[12:15], v1, s[20:23], s64 offen nt
  s_add_u32 s64, s7, 0x3800
  buffer_load_dwordx4 v[16:19], v1, s[20:23], s64 offen nt
  s_add_u32 s64, s7, 0x5400
  buffer_load_dwordx4 v[20:23], v1, s[20:23], s64 offen nt
  s_add_u32 s64, s7, 0x7000
  buffer_load_dwordx4 v[24:27], v1, s[20:23], s64 offen nt
  s_add_u32 s64, s7, 0x8c00
  buffer_load_dwordx4 v[28:31], v1, s[20:23], s64 offen nt
  s_add_u32 s64, s7, 0xa800
  buffer_load_dwordx4 v[32:35], v1, s[20:23], s64 offen nt
  s_add_u32 s64, s7, 0xc400
  buffer_load_dwordx4 v[36:39], v1, s[20:23], s64 offen nt
  s_add_u32 s64, s7, 0x70000
  buffer_load_dwordx4 v[40:43], v1, s[20:23], s64 offen nt
  s_add_u32 s64, s7, 0x71c00
  buffer_load_dwordx4 v[44:47], v1, s[20:23], s64 offen nt
  s_add_u32 s64, s7, 0x73800
  buffer_load_dwordx4 v[48:51], v1, s[20:23], s64 offen nt
  s_add_u32 s64, s7, 0x75400
  buffer_load_dwordx4 v[52:55], v1, s[20:23], s64 offen nt
  s_add_u32 s64, s7, 0x77000
  buffer_load_dwordx4 v[56:59], v1, s[20:23], s64 offen nt
  s_add_u32 s64, s7, 0x78c00
  buffer_load_dwordx4 v[60:63], v1, s[20:23], s64 offen nt
  s_add_u32 s64, s7, 0x7a800
  buffer_load_dwordx4 v[64:67], v1, s[20:23], s64 offen nt
  s_add_u32 s64, s7, 0x7c400
  buffer_load_dwordx4 v[68:71], v1, s[20:23], s64 offen nt
  s_add_u32 s64, s7, 0xe0000
  s_waitcnt vmcnt(15)
  buffer_load_dwordx4 v[72:75], v1, s[20:23], s64 offen nt
  s_add_u32 s64, s7, 0xe1c00
  s_waitcnt vmcnt(15)
  buffer_load_dwordx4 v[76:79], v1, s[20:23], s64 offen nt
  s_add_u32 s64, s7, 0xe3800
  s_waitcnt vmcnt(15)
  buffer_load_dwordx4 v[80:83], v1, s[20:23], s64 offen nt
  s_add_u32 s64, s7, 0xe5400
  s_waitcnt vmcnt(15)
  buffer_load_dwordx4 v[84:87], v1, s[20:23], s64 offen nt
  s_add_u32 s64, s7, 0xe7000
  s_waitcnt vmcnt(15)
  buffer_load_dwordx4 v[88:91], v1, s[20:23], s64 offen nt
  s_add_u32 s64, s7, 0xe8c00
  s_waitcnt vmcnt(15)
  buffer_load_dwordx4 v[92:95], v1, s[20:23], s64 offen nt
  s_add_u32 s64, s7, 0xea800
  s_waitcnt vmcnt(15)
  buffer_load_dwordx4 v[96:99], v1, s[20:23], s64 offen nt
  s_add_u32 s64, s7, 0xec400
  s_waitcnt vmcnt(15)
  buffer_load_dwordx4 v[100:103], v1, s[20:23], s64 offen nt
  s_add_u32 s64, s7, 0x150000
  s_waitcnt vmcnt(15)
  buffer_load_dwordx4 v[104:107], v1, s[20:23], s64 offen nt
  s_add_u32 s64, s7, 0x151c00
  s_waitcnt vmcnt(15)
  buffer_load_dwordx4 v[108:111], v1, s[20:23], s64 offen nt
  s_add_u32 s64, s7, 0x153800
  s_waitcnt vmcnt(15)
  buffer_load_dwordx4 v[112:115], v1, s[20:23], s64 offen nt
  s_add_u32 s64, s7, 0x155400
  s_waitcnt vmcnt(15)
  buffer_load_dwordx4 v[116:119], v1, s[20:23], s64 offen nt
  s_add_u32 s64, s7, 0x157000
  s_waitcnt vmcnt(15)
  buffer_load_dwordx4 v[120:123], v1, s[20:23], s64 offen nt
  s_add_u32 s64, s7, 0x158c00
  s_waitcnt vmcnt(15)
  buffer_load_dwordx4 v[124:127], v1, s[20:23], s64 offen nt
  s_add_u32 s64, s7, 0x15a800
  s_waitcnt vmcnt(15)
  buffer_load_dwordx4 v[128:131], v1, s[20:23], s64 offen nt
  s_add_u32 s64, s7, 0x15c400
  s_waitcnt vmcnt(15)
  buffer_load_dwordx4 v[132:135], v1, s[20:23], s64 offen nt
  v_lshrrev_b32 v1, 4, v0
  v_lshlrev_b32 v1, 5, v1
  v_and_b32 v4, 1, v0
  v_lshl_add_u32 v1, v4, 4, v1
  s_lshl_b32 s64, s5, 9
  s_add_u32 s64, s64, 2304
  v_add_u32 v1, s64, v1
  s_cbranch_execz L_vw_116
  s_waitcnt vmcnt(24)
L_vw_116:
  v_perm_b32 v136, v12, v8, s62
  v_perm_b32 v137, v20, v16, s62
  v_perm_b32 v138, v28, v24, s62
  v_perm_b32 v139, v36, v32, s62
  v_perm_b32 v140, v12, v8, s63
  v_perm_b32 v141, v20, v16, s63
  v_perm_b32 v142, v28, v24, s63
  v_perm_b32 v143, v36, v32, s63
  v_perm_b32 v144, v13, v9, s62
  v_perm_b32 v145, v21, v17, s62
  v_perm_b32 v146, v29, v25, s62
  v_perm_b32 v147, v37, v33, s62
  v_perm_b32 v148, v13, v9, s63
  v_perm_b32 v149, v21, v17, s63
  v_perm_b32 v150, v29, v25, s63
  v_perm_b32 v151, v37, v33, s63
  v_perm_b32 v152, v14, v10, s62
  v_perm_b32 v153, v22, v18, s62
  v_perm_b32 v154, v30, v26, s62
  v_perm_b32 v155, v38, v34, s62
  v_perm_b32 v156, v14, v10, s63
  v_perm_b32 v157, v22, v18, s63
  v_perm_b32 v158, v30, v26, s63
  v_perm_b32 v159, v38, v34, s63
  v_perm_b32 v160, v15, v11, s62
  v_perm_b32 v161, v23, v19, s62
  v_perm_b32 v162, v31, v27, s62
  v_perm_b32 v163, v39, v35, s62
  v_perm_b32 v164, v15, v11, s63
  v_perm_b32 v165, v23, v19, s63
  v_perm_b32 v166, v31, v27, s63
  v_perm_b32 v167, v39, v35, s63
  s_cbranch_execz L_vw_117
  s_waitcnt vmcnt(16)
L_vw_117:
  v_perm_b32 v8, v44, v40, s62
  v_perm_b32 v9, v52, v48, s62
  v_perm_b32 v10, v60, v56, s62
  v_perm_b32 v11, v68, v64, s62
  v_perm_b32 v12, v44, v40, s63
  v_perm_b32 v13, v52, v48, s63
  v_perm_b32 v14, v60, v56, s63
  v_perm_b32 v15, v68, v64, s63
  v_perm_b32 v16, v45, v41, s62
  v_perm_b32 v17, v53, v49, s62
  v_perm_b32 v18, v61, v57, s62
  v_perm_b32 v19, v69, v65, s62
  v_perm_b32 v20, v45, v41, s63
  v_perm_b32 v21, v53, v49, s63
  v_perm_b32 v22, v61, v57, s63
  v_perm_b32 v23, v69, v65, s63
  v_perm_b32 v24, v46, v42, s62
  v_perm_b32 v25, v54, v50, s62
  v_perm_b32 v26, v62, v58, s62
  v_perm_b32 v27, v70, v66, s62
  v_perm_b32 v28, v46, v42, s63
  v_perm_b32 v29, v54, v50, s63
  v_perm_b32 v30, v62, v58, s63
  v_perm_b32 v31, v70, v66, s63
  v_perm_b32 v32, v47, v43, s62
  v_perm_b32 v33, v55, v51, s62
  v_perm_b32 v34, v63, v59, s62
  v_perm_b32 v35, v71, v67, s62
  v_perm_b32 v36, v47, v43, s63
  v_perm_b32 v37, v55, v51, s63
  v_perm_b32 v38, v63, v59, s63
  v_perm_b32 v39, v71, v67, s63
  s_cbranch_execz L_vw_118
  s_waitcnt vmcnt(8)
L_vw_118:
  v_perm_b32 v40, v76, v72, s62
  v_perm_b32 v41, v84, v80, s62
  v_perm_b32 v42, v92, v88, s62
  v_perm_b32 v43, v100, v96, s62
  v_perm_b32 v44, v76, v72, s63
  v_perm_b32 v45, v84, v80, s63
  v_perm_b32 v46, v92, v88, s63
  v_perm_b32 v47, v100, v96, s63
  v_perm_b32 v48, v77, v73, s62
  v_perm_b32 v49, v85, v81, s62
  v_perm_b32 v50, v93, v89, s62
  v_perm_b32 v51, v101, v97, s62
  v_perm_b32 v52, v77, v73, s63
  v_perm_b32 v53, v85, v81, s63
  v_perm_b32 v54, v93, v89, s63
  v_perm_b32 v55, v101, v97, s63
  v_perm_b32 v56, v78, v74, s62
  v_perm_b32 v57, v86, v82, s62
  v_perm_b32 v58, v94, v90, s62
  v_perm_b32 v59, v102, v98, s62
  v_perm_b32 v60, v78, v74, s63
  v_perm_b32 v61, v86, v82, s63
  v_perm_b32 v62, v94, v90, s63
  v_perm_b32 v63, v102, v98, s63
  v_perm_b32 v64, v79, v75, s62
  v_perm_b32 v65, v87, v83, s62
  v_perm_b32 v66, v95, v91, s62
  v_perm_b32 v67, v103, v99, s62
  v_perm_b32 v68, v79, v75, s63
  v_perm_b32 v69, v87, v83, s63
  v_perm_b32 v70, v95, v91, s63
  v_perm_b32 v71, v103, v99, s63
  s_cbranch_execz L_vw_119
  s_waitcnt vmcnt(0)
L_vw_119:
  v_perm_b32 v72, v108, v104, s62
  v_perm_b32 v73, v116, v112, s62
  v_perm_b32 v74, v124, v120, s62
  v_perm_b32 v75, v132, v128, s62
  v_perm_b32 v76, v108, v104, s63
  v_perm_b32 v77, v116, v112, s63
  v_perm_b32 v78, v124, v120, s63
  v_perm_b32 v79, v132, v128, s63
  v_perm_b32 v80, v109, v105, s62
  v_perm_b32 v81, v117, v113, s62
  v_perm_b32 v82, v125, v121, s62
  v_perm_b32 v83, v133, v129, s62
  v_perm_b32 v84, v109, v105, s63
  v_perm_b32 v85, v117, v113, s63
  v_perm_b32 v86, v125, v121, s63
  v_perm_b32 v87, v133, v129, s63
  v_perm_b32 v88, v110, v106, s62
  v_perm_b32 v89, v118, v114, s62
  v_perm_b32 v90, v126, v122, s62
  v_perm_b32 v91, v134, v130, s62
  v_perm_b32 v92, v110, v106, s63
  v_perm_b32 v93, v118, v114, s63
  v_perm_b32 v94, v126, v122, s63
  v_perm_b32 v95, v134, v130, s63
  v_perm_b32 v96, v111, v107, s62
  v_perm_b32 v97, v119, v115, s62
  v_perm_b32 v98, v127, v123, s62
  v_perm_b32 v99, v135, v131, s62
  v_perm_b32 v100, v111, v107, s63
  v_perm_b32 v101, v119, v115, s63
  v_perm_b32 v102, v127, v123, s63
  v_perm_b32 v103, v135, v131, s63
  s_lshl_b32 s80, s6, 13
  s_lshl_b32 s64, s5, 10
  s_add_u32 s80, s80, s64
  s_add_u32 s80, s80, 0x200000
  s_add_u32 s81, s80, 4096
  s_mov_b32 s68, 0
L_p_120:
  s_add_u32 s68, s68, 1
  s_cmp_gt_u32 s68, 0x40000
  s_cbranch_scc1 L_fail
  s_cbranch_execz L_ps_121
  buffer_load_dwordx4 v[104:107], v2, s[16:19], s80 offen offset:0 sc1
  buffer_load_dwordx4 v[108:111], v2, s[16:19], s81 offen offset:0 sc1
  s_waitcnt vmcnt(1)
L_ps_121:
  s_mov_b64 s[70:71], -1
  v_cmp_eq_u32 vcc, s4, v105
  v_cmp_eq_u32 s[76:77], s4, v107
  s_and_b64 s[70:71], s[70:71], vcc
  s_and_b64 s[70:71], s[70:71], s[76:77]
  s_cbranch_execz L_vw_122
  s_waitcnt vmcnt(0)
L_vw_122:
  v_cmp_eq_u32 vcc, s4, v109
  v_cmp_eq_u32 s[76:77], s4, v111
  s_and_b64 s[70:71], s[70:71], vcc
  s_and_b64 s[70:71], s[70:71], s[76:77]
  s_cmp_eq_u64 s[70:71], -1
  s_cbranch_execz L_pd_123
  s_cbranch_scc1 L_pd_123
  s_sleep 100
  s_branch L_p_120
L_pd_123:
  v_lshlrev_b32 v112, 16, v104
  v_and_b32 v113, 0xffff0000, v104
  v_lshlrev_b32 v114, 16, v106
  v_and_b32 v115, 0xffff0000, v106
  v_lshlrev_b32 v116, 16, v108
  v_and_b32 v117, 0xffff0000, v108
  v_lshlrev_b32 v118, 16, v110
  v_and_b32 v119, 0xffff0000, v110
  v_add_f32 v116, 1.0, v116
  v_add_f32 v117, 1.0, v117
  v_add_f32 v118, 1.0, v118
  v_add_f32 v119, 1.0, v119
  v_cvt_pk_bf16_f32 v120, v116, v117
  v_lshlrev_b32 v116, 16, v120
  v_and_b32 v117, 0xffff0000, v120
  v_cvt_pk_bf16_f32 v120, v118, v119
  v_lshlrev_b32 v118, 16, v120
  v_and_b32 v119, 0xffff0000, v120
  s_lshl_b32 s64, s5, 9
  s_add_u32 s64, s64, 2304
  v_lshlrev_b32 v6, 3, v0
  v_add_u32 v6, s64, v6
  s_lshl_b32 s64, s5, 3
  v_mov_b32 v7, s64
L_s3_seg:
  s_lshl_b32 s80, s6, 12
  s_lshl_b32 s64, s5, 10
  s_add_u32 s80, s80, s64
  s_add_u32 s80, s80, 0x580000
  s_mov_b32 s68, 0
L_w_124:
  s_sleep 1
  s_add_u32 s68, s68, 1
  s_cmp_gt_u32 s68, 0x400000
  s_cbranch_scc1 L_fail
  ds_read_b32 v4, v3 offset:40
  s_waitcnt lgkmcnt(0)
  v_readfirstlane_b32 s67, v4
  s_nop 0
  s_cmp_ge_u32 s67, 8
  s_cbranch_execz L_wd_125
  s_cbranch_scc0 L_w_124
L_wd_125:
  s_mov_b32 s68, 0
L_pp_126:
  buffer_load_dwordx4 v[104:107], v2, s[16:19], s80 offen offset:0 sc1
  s_add_u32 s68, s68, 1
  s_cmp_gt_u32 s68, 0x80000
  s_cbranch_scc1 L_fail
  s_mov_b64 s[70:71], -1
  s_waitcnt vmcnt(0)
  v_cmp_eq_u32 vcc, s4, v105
  v_cmp_eq_u32 s[76:77], s4, v107
  s_and_b64 s[70:71], s[70:71], vcc
  s_and_b64 s[70:71], s[70:71], s[76:77]
  s_cmp_eq_u64 s[70:71], -1
  s_cbranch_scc0 L_pp_126
  v_lshlrev_b32 v108, 16, v104
  v_and_b32 v109, 0xffff0000, v104
  v_lshlrev_b32 v110, 16, v106
  v_and_b32 v111, 0xffff0000, v106
  v_add_f32 v122, v108, v109
  v_mul_f32 v123, v108, v108
  v_fmac_f32 v123, v109, v109
  v_add_f32 v122, v122, v110
  v_fmac_f32 v123, v110, v110
  v_add_f32 v122, v122, v111
  v_fmac_f32 v123, v111, v111
  s_nop 0
  v_add_f32_dpp v122, v122, v122 quad_perm:[1,0,3,2] row_mask:0xf bank_mask:0xf
  v_add_f32_dpp v123, v123, v123 quad_perm:[1,0,3,2] row_mask:0xf bank_mask:0xf
  s_nop 0
  v_add_f32_dpp v122, v122, v122 quad_perm:[2,3,0,1] row_mask:0xf bank_mask:0xf
  v_add_f32_dpp v123, v123, v123 quad_perm:[2,3,0,1] row_mask:0xf bank_mask:0xf
  s_nop 0
  v_add_f32_dpp v122, v122, v122 row_half_mirror row_mask:0xf bank_mask:0xf
  v_add_f32_dpp v123, v123, v123 row_half_mirror row_mask:0xf bank_mask:0xf
  s_nop 0
  v_add_f32_dpp v122, v122, v122 row_ror:8 row_mask:0xf bank_mask:0xf
  v_add_f32_dpp v123, v123, v123 row_ror:8 row_mask:0xf bank_mask:0xf
  v_mov_b32 v120, v122
  v_mov_b32 v121, v123
  s_nop 0
  v_permlane16_swap_b32 v122, v120
  v_permlane16_swap_b32 v123, v121
  v_add_f32 v122, v122, v120
  v_add_f32 v123, v123, v121
  v_mov_b32 v120, v122
  v_mov_b32 v121, v123
  s_nop 0
  v_permlane32_swap_b32 v122, v120
  v_permlane32_swap_b32 v123, v121
  v_add_f32 v122, v122, v120
  v_add_f32 v123, v123, v121
  s_and_b64 exec, s[26:27], 0x1
  ds_write_b64 v7, v[122:123] offset:5888
  s_mov_b64 exec, s[26:27]
  s_mov_b32 s68, 0
L_ls_127:
  ds_read_b128 v[128:131], v3 offset:5888
  ds_read_b128 v[132:135], v3 offset:5904
  s_add_u32 s68, s68, 1
  s_cmp_gt_u32 s68, 0x400000
  s_cbranch_scc1 L_fail
  s_waitcnt lgkmcnt(0)
  v_max3_u32 v4, v129, v131, v133
  v_max_u32 v4, v4, v135
  v_cmp_eq_u32 vcc, -1, v4
  s_nop 0
  s_cmp_eq_u64 vcc, 0
  s_cbranch_scc0 L_ls_127
  v_add_f32 v122, v128, v130
  v_add_f32 v123, v129, v131
  v_add_f32 v128, v132, v134
  v_add_f32 v129, v133, v135
  v_add_f32 v122, v122, v128
  v_add_f32 v123, v123, v129
  v_mul_f32 v124, 0x3a800000, v122
  v_mul_f32 v125, 0x3a800000, v123
  v_fma_f32 v125, -v124, v124, v125
  v_max_f32 v125, 0, v125
  v_cvt_pk_bf16_f32 v120, v124, v125
  v_lshlrev_b32 v124, 16, v120
  v_and_b32 v125, 0xffff0000, v120
  v_add_f32 v125, 0x3727c5ac, v125
  v_cvt_pk_bf16_f32 v125, v125, v125
  v_and_b32 v125, 0xffff0000, v125
  v_sqrt_f32 v125, v125
  s_nop 0
  v_cvt_pk_bf16_f32 v125, v125, v125
  v_and_b32 v125, 0xffff0000, v125
  v_rcp_f32 v126, v125
  v_sub_f32 v108, v108, v124
  v_sub_f32 v109, v109, v124
  v_sub_f32 v110, v110, v124
  v_sub_f32 v111, v111, v124
  v_cvt_pk_bf16_f32 v120, v108, v109
  v_lshlrev_b32 v108, 16, v120
  v_and_b32 v109, 0xffff0000, v120
  v_cvt_pk_bf16_f32 v120, v110, v111
  v_lshlrev_b32 v110, 16, v120
  v_and_b32 v111, 0xffff0000, v120
  v_mul_f32 v120, v108, v126
  v_fma_f32 v121, -v120, v125, v108
  v_fma_f32 v108, v121, v126, v120
  v_mul_f32 v120, v109, v126
  v_fma_f32 v121, -v120, v125, v109
  v_fma_f32 v109, v121, v126, v120
  v_mul_f32 v120, v110, v126
  v_fma_f32 v121, -v120, v125, v110
  v_fma_f32 v110, v121, v126, v120
  v_mul_f32 v120, v111, v126
  v_fma_f32 v121, -v120, v125, v111
  v_fma_f32 v111, v121, v126, v120
  v_cvt_pk_bf16_f32 v120, v108, v109
  v_lshlrev_b32 v108, 16, v120
  v_and_b32 v109, 0xffff0000, v120
  v_cvt_pk_bf16_f32 v120, v110, v111
  v_lshlrev_b32 v110, 16, v120
  v_and_b32 v111, 0xffff0000, v120
  v_mul_f32 v108, v108, v116
  v_mul_f32 v109, v109, v117
  v_mul_f32 v110, v110, v118
  v_mul_f32 v111, v111, v119
  v_cvt_pk_bf16_f32 v120, v108, v109
  v_lshlrev_b32 v108, 16, v120
  v_and_b32 v109, 0xffff0000, v120
  v_cvt_pk_bf16_f32 v121, v110, v111
  v_lshlrev_b32 v110, 16, v121
  v_and_b32 v111, 0xffff0000, v121
  v_add_f32 v108, v108, v112
  v_add_f32 v109, v109, v113
  v_add_f32 v110, v110, v114
  v_add_f32 v111, v111, v115
  v_cvt_pk_bf16_f32 v120, v108, v109
  v_lshlrev_b32 v108, 16, v120
  v_and_b32 v109, 0xffff0000, v120
  v_cvt_pk_bf16_f32 v121, v110, v111
  v_lshlrev_b32 v110, 16, v121
  v_and_b32 v111, 0xffff0000, v121
  v_add_f32 v122, v108, v109
  v_mul_f32 v123, v108, v108
  v_fmac_f32 v123, v109, v109
  v_add_f32 v122, v122, v110
  v_fmac_f32 v123, v110, v110
  v_add_f32 v122, v122, v111
  v_fmac_f32 v123, v111, v111
  s_nop 0
  v_add_f32_dpp v122, v122, v122 quad_perm:[1,0,3,2] row_mask:0xf bank_mask:0xf
  v_add_f32_dpp v123, v123, v123 quad_perm:[1,0,3,2] row_mask:0xf bank_mask:0xf
  s_nop 0
  v_add_f32_dpp v122, v122, v122 quad_perm:[2,3,0,1] row_mask:0xf bank_mask:0xf
  v_add_f32_dpp v123, v123, v123 quad_perm:[2,3,0,1] row_mask:0xf bank_mask:0xf
  s_nop 0
  v_add_f32_dpp v122, v122, v122 row_half_mirror row_mask:0xf bank_mask:0xf
  v_add_f32_dpp v123, v123, v123 row_half_mirror row_mask:0xf bank_mask:0xf
  s_nop 0
  v_add_f32_dpp v122, v122, v122 row_ror:8 row_mask:0xf bank_mask:0xf
  v_add_f32_dpp v123, v123, v123 row_ror:8 row_mask:0xf bank_mask:0xf
  v_mov_b32 v120, v122
  v_mov_b32 v121, v123
  s_nop 0
  v_permlane16_swap_b32 v122, v120
  v_permlane16_swap_b32 v123, v121
  v_add_f32 v122, v122, v120
  v_add_f32 v123, v123, v121
  v_mov_b32 v120, v122
  v_mov_b32 v121, v123
  s_nop 0
  v_permlane32_swap_b32 v122, v120
  v_permlane32_swap_b32 v123, v121
  v_add_f32 v122, v122, v120
  v_add_f32 v123, v123, v121
  s_and_b64 exec, s[26:27], 0x1
  ds_write_b64 v7, v[122:123] offset:5920
  s_mov_b64 exec, s[26:27]
  s_mov_b32 s68, 0
L_ls_128:
  ds_read_b128 v[128:131], v3 offset:5920
  ds_read_b128 v[132:135], v3 offset:5936
  s_add_u32 s68, s68, 1
  s_cmp_gt_u32 s68, 0x400000
  s_cbranch_scc1 L_fail
  s_waitcnt lgkmcnt(0)
  v_max3_u32 v4, v129, v131, v133
  v_max_u32 v4, v4, v135
  v_cmp_eq_u32 vcc, -1, v4
  s_nop 0
  s_cmp_eq_u64 vcc, 0
  s_cbranch_scc0 L_ls_128
  v_add_f32 v122, v128, v130
  v_add_f32 v123, v129, v131
  v_add_f32 v128, v132, v134
  v_add_f32 v129, v133, v135
  v_add_f32 v122, v122, v128
  v_add_f32 v123, v123, v129
  v_mul_f32 v124, 0x3a800000, v122
  v_mul_f32 v125, 0x3a800000, v123
  v_fma_f32 v125, -v124, v124, v125
  v_max_f32 v125, 0, v125
  v_cvt_pk_bf16_f32 v120, v124, v125
  v_lshlrev_b32 v124, 16, v120
  v_and_b32 v125, 0xffff0000, v120
  v_add_f32 v125, 0x3727c5ac, v125
  v_cvt_pk_bf16_f32 v125, v125, v125
  v_and_b32 v125, 0xffff0000, v125
  v_sqrt_f32 v125, v125
  s_nop 0
  v_cvt_pk_bf16_f32 v125, v125, v125
  v_and_b32 v125, 0xffff0000, v125
  v_rcp_f32 v126, v125
  v_sub_f32 v108, v108, v124
  v_sub_f32 v109, v109, v124
  v_sub_f32 v110, v110, v124
  v_sub_f32 v111, v111, v124
  v_cvt_pk_bf16_f32 v120, v108, v109
  v_lshlrev_b32 v108, 16, v120
  v_and_b32 v109, 0xffff0000, v120
  v_cvt_pk_bf16_f32 v120, v110, v111
  v_lshlrev_b32 v110, 16, v120
  v_and_b32 v111, 0xffff0000, v120
  v_mul_f32 v120, v108, v126
  v_fma_f32 v121, -v120, v125, v108
  v_fma_f32 v108, v121, v126, v120
  v_mul_f32 v120, v109, v126
  v_fma_f32 v121, -v120, v125, v109
  v_fma_f32 v109, v121, v126, v120
  v_mul_f32 v120, v110, v126
  v_fma_f32 v121, -v120, v125, v110
  v_fma_f32 v110, v121, v126, v120
  v_mul_f32 v120, v111, v126
  v_fma_f32 v121, -v120, v125, v111
  v_fma_f32 v111, v121, v126, v120
  v_cvt_pk_bf16_f32 v120, v108, v109
  v_lshlrev_b32 v108, 16, v120
  v_and_b32 v109, 0xffff0000, v120
  v_cvt_pk_bf16_f32 v120, v110, v111
  v_lshlrev_b32 v110, 16, v120
  v_and_b32 v111, 0xffff0000, v120
  v_cvt_pk_bf16_f32 v120, v108, v109
  v_cvt_pk_bf16_f32 v121, v110, v111
  ds_write_b64 v6, v[120:121]
  s_waitcnt vmcnt(0)
  ds_read_b128 v[120:123], v1 offset:0
  ds_read_b128 v[124:127], v1 offset:128
  ds_read_b128 v[128:131], v1 offset:256
  ds_read_b128 v[132:135], v1 offset:384
  s_cbranch_execz L_ms_129
  s_waitcnt lgkmcnt(3)
  v_mfma_f32_16x16x32_bf16 v[104:107], v[120:123], v[136:139], 0
  v_mfma_f32_16x16x32_bf16 v[108:111], v[120:123], v[140:143], 0
  v_mfma_f32_16x16x32_bf16 v[112:115], v[120:123], v[144:147], 0
  v_mfma_f32_16x16x32_bf16 v[116:119], v[120:123], v[148:151], 0
  s_waitcnt lgkmcnt(2)
  v_mfma_f32_16x16x32_bf16 v[104:107], v[124:127], v[8:11], v[104:107]
  v_mfma_f32_16x16x32_bf16 v[108:111], v[124:127], v[12:15], v[108:111]
  v_mfma_f32_16x16x32_bf16 v[112:115], v[124:127], v[16:19], v[112:115]
  v_mfma_f32_16x16x32_bf16 v[116:119], v[124:127], v[20:23], v[116:119]
  s_waitcnt lgkmcnt(1)
  v_mfma_f32_16x16x32_bf16 v[104:107], v[128:131], v[40:43], v[104:107]
  v_mfma_f32_16x16x32_bf16 v[108:111], v[128:131], v[44:47], v[108:111]
  v_mfma_f32_16x16x32_bf16 v[112:115], v[128:131], v[48:51], v[112:115]
  v_mfma_f32_16x16x32_bf16 v[116:119], v[128:131], v[52:55], v[116:119]
  s_waitcnt lgkmcnt(0)
  v_mfma_f32_16x16x32_bf16 v[104:107], v[132:135], v[72:75], v[104:107]
  v_mfma_f32_16x16x32_bf16 v[108:111], v[132:135], v[76:79], v[108:111]
  v_mfma_f32_16x16x32_bf16 v[112:115], v[132:135], v[80:83], v[112:115]
  v_mfma_f32_16x16x32_bf16 v[116:119], v[132:135], v[84:87], v[116:119]
  v_mfma_f32_16x16x32_bf16 v[136:139], v[120:123], v[152:155], 0
  v_mfma_f32_16x16x32_bf16 v[140:143], v[120:123], v[156:159], 0
  v_mfma_f32_16x16x32_bf16 v[144:147], v[120:123], v[160:163], 0
  v_mfma_f32_16x16x32_bf16 v[148:151], v[120:123], v[164:167], 0
  v_mfma_f32_16x16x32_bf16 v[136:139], v[124:127], v[24:27], v[136:139]
  v_mfma_f32_16x16x32_bf16 v[140:143], v[124:127], v[28:31], v[140:143]
  v_mfma_f32_16x16x32_bf16 v[144:147], v[124:127], v[32:35], v[144:147]
  v_mfma_f32_16x16x32_bf16 v[148:151], v[124:127], v[36:39], v[148:151]
  v_mfma_f32_16x16x32_bf16 v[136:139], v[128:131], v[56:59], v[136:139]
  v_mfma_f32_16x16x32_bf16 v[140:143], v[128:131], v[60:63], v[140:143]
  v_mfma_f32_16x16x32_bf16 v[144:147], v[128:131], v[64:67], v[144:147]
  v_mfma_f32_16x16x32_bf16 v[148:151], v[128:131], v[68:71], v[148:151]
  v_mfma_f32_16x16x32_bf16 v[136:139], v[132:135], v[88:91], v[136:139]
  v_mfma_f32_16x16x32_bf16 v[140:143], v[132:135], v[92:95], v[140:143]
  v_mfma_f32_16x16x32_bf16 v[144:147], v[132:135], v[96:99], v[144:147]
  v_mfma_f32_16x16x32_bf16 v[148:151], v[132:135], v[100:103], v[148:151]
L_ms_129:
  v_add_f32_dpp v120, v105, v104 row_ror:8 row_mask:0xf bank_mask:0xf
  v_add_f32_dpp v121, v109, v108 row_ror:8 row_mask:0xf bank_mask:0xf
  v_add_f32_dpp v122, v113, v112 row_ror:8 row_mask:0xf bank_mask:0xf
  v_add_f32_dpp v123, v117, v116 row_ror:8 row_mask:0xf bank_mask:0xf
  s_nop 0
  v_add_f32_dpp v124, v137, v136 row_ror:8 row_mask:0xf bank_mask:0xf
  v_add_f32_dpp v125, v141, v140 row_ror:8 row_mask:0xf bank_mask:0xf
  v_add_f32_dpp v126, v145, v144 row_ror:8 row_mask:0xf bank_mask:0xf
  v_add_f32_dpp v127, v149, v148 row_ror:8 row_mask:0xf bank_mask:0xf
  s_lshl_b32 s64, s5, 8
  v_lshlrev_b32 v5, 5, v0
  v_add_u32 v5, s64, v5
  s_and_b64 exec, s[26:27], 0xff
  ds_write_b128 v5, v[120:123] offset:4352
  ds_write_b128 v5, v[124:127] offset:4368
  s_mov_b64 exec, s[26:27]
  s_branch L_end
L_warm_stream:
  s_branch L_end
L_dryret:
  s_branch L_end
L_fail:
  v_mov_b32 v4, 0xdead
  v_mov_b32 v5, 0
  s_mov_b64 exec, 1
  global_store_dword v5, v4, s[58:59]
  s_mov_b64 exec, -1
L_end:
L_exit:
  s_endpgm
.section .rodata,"a"
.p2align 6
.amdhsa_kernel adaLN_cond__gqa_block_cached__mixer_channel_mlp__decode_kernel
  .amdhsa_next_free_vgpr 168
  .amdhsa_next_free_sgpr 102
  .amdhsa_accum_offset 168
  .amdhsa_group_segment_fixed_size 0
  .amdhsa_kernarg_size 120
  .amdhsa_user_sgpr_count 2
  .amdhsa_user_sgpr_kernarg_segment_ptr 1
  .amdhsa_system_sgpr_workgroup_id_x 1
.end_amdhsa_kernel
```
